```python
import torch

def _softmax(x, axis=-1):
    return torch.softmax(x, dim=axis)
def _gelu(x):
    return torch.nn.functional.gelu(x, approximate="tanh")
def _silu(x):
    return torch.nn.functional.silu(x)
def _sigmoid(x):
    return torch.sigmoid(x)
def _layernorm(x, axis=-1, eps=1e-5):
    m = x.mean(dim=axis, keepdim=True)
    v = x.var(dim=axis, keepdim=True, unbiased=False)
    return (x - m) / torch.sqrt(v + eps)
def _scatter_add(tgt, idx, src, axis=0):
    return tgt.clone().index_add_(axis, idx, src)
def _segment_sum(src, seg, n):
    out = torch.zeros((n,) + src.shape[1:], dtype=src.dtype)
    return out.index_add_(0, seg, src)
def _pad(x, pw):
    flat = tuple(v for pair in reversed(pw) for v in pair)
    return torch.nn.functional.pad(x, flat)

kernel_name = 'gated_mix__ssm_conv_s5__dense_activation_relu__prompt'

def setup_inputs():

    _w = (lambda a: (lambda t: t.to(torch.bfloat16) if t.is_floating_point() else t)(torch.as_tensor(a)))
    def _A_setup():
        B, S, D = 1, 2048, 640
        P = D
        Lambda_re = -0.5 * (lambda _x: torch.exp(torch.as_tensor(_x)))((lambda *s: torch.randn(*s, dtype=torch.bfloat16) * 0.8)(P))
        Lambda_im = (lambda *s: torch.randn(*s, dtype=torch.bfloat16) * 0.8)(P) * 1.0
        B_re = (lambda *s: torch.randn(*s, dtype=torch.bfloat16) * 0.8)(P, D) * (D ** -0.5)
        B_im = (lambda *s: torch.randn(*s, dtype=torch.bfloat16) * 0.8)(P, D) * (D ** -0.5)
        C_re = (lambda *s: torch.randn(*s, dtype=torch.bfloat16) * 0.8)(D, P) * (P ** -0.5)
        C_im = (lambda *s: torch.randn(*s, dtype=torch.bfloat16) * 0.8)(D, P) * (P ** -0.5)
        log_dt = (lambda *s: torch.randn(*s, dtype=torch.bfloat16) * 0.8)(P) * 0.3 - 2.0
        Dskip = (lambda *s: torch.randn(*s, dtype=torch.bfloat16) * 0.8)(D)
        return {
            "x": _w((lambda *s: torch.randn(*s, dtype=torch.bfloat16) * 0.05)(B, S, D)),
            "Lambda_re": _w(Lambda_re),
            "Lambda_im": _w(Lambda_im),
            "B_re": _w(B_re),
            "B_im": _w(B_im),
            "C_re": _w(C_re),
            "C_im": _w(C_im),
            "log_dt": _w(log_dt),
            "Dskip": _w(Dskip),
        }
    _A_in = _A_setup()

    def _B_setup():
        B, S, D, Dff = 1, 2048, 640, 1536
        return {
            "x": _w((lambda *s: torch.randn(*s, dtype=torch.bfloat16) * 0.05)(B, S, D)),
            "w1": _w((lambda *s: torch.randn(*s, dtype=torch.bfloat16) * 0.05)(D, Dff)),
            "w2": _w((lambda *s: torch.randn(*s, dtype=torch.bfloat16) * 0.05)(Dff, D)),
        }
    _B_in = _B_setup()

    return {
        "A_x": _A_in["x"],
        "A_Lambda_re": _A_in["Lambda_re"],
        "A_Lambda_im": _A_in["Lambda_im"],
        "A_B_re": _A_in["B_re"],
        "A_B_im": _A_in["B_im"],
        "A_C_re": _A_in["C_re"],
        "A_C_im": _A_in["C_im"],
        "A_log_dt": _A_in["log_dt"],
        "A_Dskip": _A_in["Dskip"],
        "B_x": _B_in["x"],
        "B_w1": _B_in["w1"],
        "B_w2": _B_in["w2"],
        "gate_w": _w((lambda *s: torch.randn(*s, dtype=torch.bfloat16) * 0.05)(640) * 16.0),
    }

def reference(A_x, A_Lambda_re, A_Lambda_im, A_B_re, A_B_im, A_C_re, A_C_im, A_log_dt, A_Dskip, B_x, B_w1, B_w2, gate_w):
    def _A_ref(x, Lambda_re, Lambda_im, B_re, B_im, C_re, C_im, log_dt, Dskip):
        Bsz, L, H = x.shape
        Lam = Lambda_re + 1j * Lambda_im
        Bmat = B_re + 1j * B_im
        Cmat = C_re + 1j * C_im
        dt = torch.exp(log_dt)
        Lam_bar = torch.exp(dt * Lam)
        B_bar = ((Lam_bar - 1.0) / Lam)[:, None] * Bmat
        Bu = torch.einsum("bld,pd->blp", x + 0j, B_bar)
        h = torch.zeros_like(Bu[:, 0, :])
        hs = []
        for t in range(L):
            h = Lam_bar[None, :] * h + Bu[:, t, :]
            hs.append(h)
        hseq = torch.stack(hs, 1)
        y = 2.0 * torch.einsum("blp,dp->bld", hseq, Cmat).real + x * Dskip[None, None, :]
        return y

    def _B_ref(x, w1, w2):
        h = torch.einsum("bsd,df->bsf", x, w1)
        zero = torch.zeros_like(h)
        h = torch.maximum(h, zero)
        return torch.einsum("bsf,fd->bsd", h, w2)

    x = A_x
    g = _sigmoid((x * gate_w).sum(-1, keepdims=True))
    a = _A_ref(x, A_Lambda_re, A_Lambda_im, A_B_re, A_B_im, A_C_re, A_C_im, A_log_dt, A_Dskip)
    b = _B_ref(x, B_w1, B_w2)
    return g * a + (1 - g) * b
```

```asm
; @launch grid=(256,1,1) block=(256,1,1) lds=163840
.amdgcn_target "amdgcn-amd-amdhsa--gfx950"
.text
.globl gated_mix__ssm_conv_s5__dense_activation_relu__prompt_kernel
.p2align 8
.type gated_mix__ssm_conv_s5__dense_activation_relu__prompt_kernel,@function
gated_mix__ssm_conv_s5__dense_activation_relu__prompt_kernel:
    s_cmp_ge_u32 s2, 256
    s_cbranch_scc1 L_exit
    s_load_dwordx16 s[4:19], s[0:1], 0
    s_load_dwordx16 s[20:35], s[0:1], 64
    s_getpc_b64 s[92:93]
L_pc:
    s_lshr_b32 s90, s2, 3
    s_lshl_b32 s90, s90, 2
    v_lshrrev_b32 v1, 6, v0
    v_add_u32 v1, s90, v1
    v_mul_u32_u24 v1, 3, v1
    v_and_b32 v2, 63, v0
    v_min_u32 v2, 2, v2
    v_add_u32 v1, v1, v2
    v_lshlrev_b32 v1, 7, v1
    v_min_u32 v1, L_exit-L_pc, v1
    global_load_dword v47, v1, s[92:93]
    s_and_b32 s90, s2, 7
    s_lshr_b32 s91, s2, 3
    s_lshr_b32 s92, s90, 1
    s_and_b32 s73, s90, 1
    s_lshl_b32 s93, s92, 2
    s_lshr_b32 s94, s91, 3
    s_add_u32 s67, s93, s94
    s_and_b32 s74, s91, 7
    s_lshl_b32 s93, s73, 3
    s_add_u32 s72, s93, s74
    s_lshl_b32 s93, s92, 3
    s_lshr_b32 s94, s91, 2
    s_add_u32 s70, s93, s94
    s_lshl_b32 s93, s73, 2
    s_and_b32 s94, s91, 3
    s_add_u32 s71, s93, s94
    v_lshrrev_b32 v1, 6, v0
    v_and_b32 v0, 63, v0
    v_readfirstlane_b32 s66, v1
    s_mul_i32 s93, s73, 6
    s_add_u32 s69, s93, s74
    s_lshl_b32 s93, s73, 1
    s_add_u32 s93, s93, s74
    s_sub_u32 s93, s93, 6
    s_lshl_b32 s93, s93, 1
    s_add_u32 s93, s93, 12
    s_cmp_lt_u32 s74, 6
    s_cselect_b32 s68, s69, s93
    s_and_b32 s90, s67, 3
    s_mul_i32 s90, s90, 1
    s_lshr_b32 s91, s74, 1
    s_mul_i32 s91, s91, 2
    s_add_u32 s90, s90, s91
    s_and_b32 s91, s74, 1
    s_mul_i32 s91, s91, 0
    s_add_u32 s90, s90, s91
    s_mul_i32 s91, s73, 5
    s_add_u32 s90, s90, s91
    s_lshr_b32 s91, s67, 2
    s_mul_i32 s91, s91, 2
    s_add_u32 s90, s90, s91
    s_mul_hi_u32 s91, s90, 0x1999999a
    s_mul_i32 s91, s91, 10
    s_sub_u32 s90, s90, s91
    s_cmp_ge_u32 s90, 10
    s_cselect_b32 s91, 10, 0
    s_sub_u32 s75, s90, s91
    s_lshl_b32 s76, s75, 7
    s_add_u32 s77, s76, 128
    s_cmp_ge_u32 s77, 1280
    s_cselect_b32 s77, 0, s77
    s_add_u32 s78, s77, 128
    s_cmp_ge_u32 s78, 1280
    s_cselect_b32 s78, 0, s78
    s_add_u32 s79, s78, 128
    s_cmp_ge_u32 s79, 1280
    s_cselect_b32 s79, 0, s79
    s_add_u32 s80, s79, 128
    s_cmp_ge_u32 s80, 1280
    s_cselect_b32 s80, 0, s80
    s_add_u32 s81, s80, 128
    s_cmp_ge_u32 s81, 1280
    s_cselect_b32 s81, 0, s81
    s_add_u32 s82, s81, 128
    s_cmp_ge_u32 s82, 1280
    s_cselect_b32 s82, 0, s82
    s_add_u32 s83, s82, 128
    s_cmp_ge_u32 s83, 1280
    s_cselect_b32 s83, 0, s83
    s_add_u32 s84, s83, 128
    s_cmp_ge_u32 s84, 1280
    s_cselect_b32 s84, 0, s84
    s_add_u32 s85, s84, 128
    s_cmp_ge_u32 s85, 1280
    s_cselect_b32 s85, 0, s85
    s_lshl_b32 s99, s66, 10
    v_lshrrev_b32 v64, 3, v0
    v_and_b32 v65, 7, v0
    v_lshrrev_b32 v66, 1, v64
    v_xor_b32 v66, v66, v65
    v_mul_u32_u24 v67, 1280, v64
    v_lshl_add_u32 v60, v66, 4, v67
    v_xor_b32 v61, 64, v60
    v_add_u32 v61, 10240, v61
    s_lshl_b32 s90, s67, 2
    s_add_u32 s90, s90, s66
    s_mul_i32 s90, s90, 40960
    v_add_u32 v48, s90, v60
    v_add_u32 v49, s90, v61
    v_add_u32 v50, 20480, v48
    v_add_u32 v51, 20480, v49
    s_lshl_b32 s90, s66, 3
    v_add_u32 v66, s90, v64
    v_and_b32 v67, 19, v66
    v_bfe_u32 v68, v66, 2, 1
    v_lshl_add_u32 v67, v68, 3, v67
    v_bfe_u32 v68, v66, 3, 1
    v_lshl_add_u32 v67, v68, 2, v67
    v_mul_u32_u24 v67, 1280, v67
    v_bfe_u32 v68, v66, 1, 3
    v_xor_b32 v68, v68, v65
    v_lshl_add_u32 v3, v68, 4, v67
    s_mul_i32 s90, s68, 40960
    v_add_u32 v3, s90, v3
    v_and_b32 v66, 31, v0
    v_and_b32 v67, 19, v66
    v_bfe_u32 v68, v66, 2, 1
    v_lshl_add_u32 v67, v68, 3, v67
    v_bfe_u32 v68, v66, 3, 1
    v_lshl_add_u32 v67, v68, 2, v67
    v_lshlrev_b32 v56, 1, v67
    s_lshl_b32 s90, s75, 3
    v_add_u32 v57, s90, v0
    v_subrev_u32 v66, 80, v57
    v_cmp_le_u32 vcc, 80, v57
    s_nop 1
    v_cndmask_b32 v57, v57, v66, vcc
    v_add_u32 v58, 64, v57
    v_subrev_u32 v66, 80, v58
    v_cmp_le_u32 vcc, 80, v58
    s_nop 1
    v_cndmask_b32 v58, v58, v66, vcc
    v_lshlrev_b32 v57, 4, v57
    v_lshlrev_b32 v58, 4, v58
    v_cmp_gt_u32 vcc, 16, v0
    s_nop 1
    v_cndmask_b32 v58, 0x40000000, v58, vcc
    s_waitcnt lgkmcnt(0)
    s_load_dword s3, s[34:35], 0x0
    s_mov_b32 s36, s4
    s_and_b32 s37, s5, 0xffff
    s_mov_b32 s38, 0x280000
    s_mov_b32 s39, 0x20000
    s_mov_b32 s44, s10
    s_and_b32 s45, s11, 0xffff
    s_mov_b32 s46, 0xc8000
    s_mov_b32 s47, 0x20000
    s_mov_b32 s60, s28
    s_and_b32 s61, s29, 0xffff
    s_mov_b32 s62, 0x500
    s_mov_b32 s63, 0x20000
    s_lshl_b32 s4, s66, 14
    s_add_u32 s4, s4, 81920
    s_cmp_ge_u32 s74, 6
    s_cbranch_scc1 L_typeB
    s_mov_b32 s48, s12
    s_and_b32 s49, s13, 0xffff
    s_mov_b32 s50, 0xc8000
    s_mov_b32 s51, 0x20000
    s_add_u32 m0, s4, 0
    s_nop 0
    buffer_load_dwordx4 v48, s[36:39], s76 offen lds
    s_add_u32 m0, s4, 1024
    s_nop 0
    buffer_load_dwordx4 v49, s[36:39], s76 offen lds
    s_add_u32 m0, s4, 2048
    s_nop 0
    buffer_load_dwordx4 v50, s[36:39], s76 offen lds
    s_add_u32 m0, s4, 3072
    s_nop 0
    buffer_load_dwordx4 v51, s[36:39], s76 offen lds
    s_add_u32 m0, s99, 0
    s_nop 0
    buffer_load_dwordx4 v3, s[44:47], s76 offen lds
    s_add_u32 m0, s99, 20480
    s_nop 0
    buffer_load_dwordx4 v3, s[48:51], s76 offen lds
    s_add_u32 m0, s4, 4096
    s_nop 0
    buffer_load_dwordx4 v48, s[36:39], s77 offen lds
    s_add_u32 m0, s4, 5120
    s_nop 0
    buffer_load_dwordx4 v49, s[36:39], s77 offen lds
    s_add_u32 m0, s4, 6144
    s_nop 0
    buffer_load_dwordx4 v50, s[36:39], s77 offen lds
    s_add_u32 m0, s4, 7168
    s_nop 0
    buffer_load_dwordx4 v51, s[36:39], s77 offen lds
    s_add_u32 m0, s99, 4096
    s_nop 0
    buffer_load_dwordx4 v3, s[44:47], s77 offen lds
    s_add_u32 m0, s99, 24576
    s_nop 0
    buffer_load_dwordx4 v3, s[48:51], s77 offen lds
    s_add_u32 s90, s68, 0
    s_lshl_b32 s90, s90, 6
    v_add_u32 v59, s90, v56
    global_load_ushort v26, v59, s[6:7]
    global_load_ushort v27, v59, s[8:9]
    global_load_ushort v37, v59, s[18:19]
    s_mov_b32 m0, 147456
    s_nop 0
    buffer_load_dwordx4 v57, s[60:63], 0 offen lds
    s_mov_b32 m0, 148480
    s_nop 0
    buffer_load_dwordx4 v58, s[60:63], 0 offen lds
    v_and_b32 v80, 31, v0
    v_lshrrev_b32 v81, 5, v0
    v_bfe_u32 v83, v80, 2, 1
    v_lshlrev_b32 v83, 4, v83
    v_and_b32 v82, 3, v80
    v_add_u32 v82, v82, v83
    v_lshrrev_b32 v83, 3, v80
    v_lshl_add_u32 v82, v83, 2, v82
    v_bfe_u32 v83, v82, 1, 3
    v_lshlrev_b32 v84, 1, v81
    v_xor_b32 v83, v83, v84
    v_lshlrev_b32 v82, 7, v82
    v_add_u32 v82, s4, v82
    v_xor_b32 v52, 0, v83
    v_lshl_add_u32 v52, v52, 4, v82
    v_xor_b32 v53, 1, v83
    v_lshl_add_u32 v53, v53, 4, v82
    v_xor_b32 v54, 4, v83
    v_lshl_add_u32 v54, v54, 4, v82
    v_xor_b32 v55, 5, v83
    v_lshl_add_u32 v55, v55, 4, v82
    v_lshlrev_b32 v11, 5, v81
    v_add_u32 v11, 147456, v11
    v_bfe_u32 v82, v80, 1, 3
    v_xor_b32 v82, v82, v84
    v_lshlrev_b32 v83, 7, v80
    v_xor_b32 v16, 0, v82
    v_lshl_add_u32 v16, v16, 4, v83
    v_xor_b32 v17, 1, v82
    v_lshl_add_u32 v17, v17, 4, v83
    v_xor_b32 v18, 4, v82
    v_lshl_add_u32 v18, v18, 4, v83
    v_xor_b32 v19, 5, v82
    v_lshl_add_u32 v19, v19, 4, v83
    v_add_u32 v92, 61440, v16
    v_add_u32 v93, 61440, v17
    v_add_u32 v94, 61440, v18
    v_add_u32 v95, 61440, v19
    s_mov_b32 s40, s34
    s_and_b32 s41, s35, 0xffff
    s_mov_b32 s42, 0x10000000
    s_mov_b32 s43, 0x20000
    s_mov_b32 s52, s24
    s_and_b32 s53, s25, 0xffff
    s_mov_b32 s54, 0x1e0000
    s_mov_b32 s55, 0x20000
    s_mov_b32 s56, s26
    s_and_b32 s57, s27, 0xffff
    s_mov_b32 s58, 0x1e0000
    s_mov_b32 s59, 0x20000
    s_lshl_b32 s90, s75, 3
    s_add_u32 s90, s90, s66
    s_mul_i32 s90, s90, 24576
    s_lshl_b32 s91, s69, 8
    s_add_u32 s28, s90, s91
    v_lshrrev_b32 v80, 3, v0
    v_mul_u32_u24 v81, 3072, v80
    v_bfe_u32 v80, v80, 1, 1
    v_lshlrev_b32 v80, 2, v80
    v_and_b32 v82, 7, v0
    v_xor_b32 v80, v80, v82
    v_lshl_add_u32 v4, v80, 4, v81
    v_lshrrev_b32 v59, 1, v0
    v_mul_u32_u24 v59, 1280, v59
    v_and_b32 v84, 1, v0
    v_lshl_add_u32 v59, v84, 4, v59
    s_lshl_b32 s90, s2, 2
    s_add_u32 s98, s90, s66
    s_cmp_lt_u32 s98, 960
    s_cselect_b32 s91, 0, 0x40000000
    v_add_u32 v59, s91, v59
    v_lshlrev_b32 v14, 4, v0
    v_add_u32 v1, s91, v14
    s_min_u32 s91, s98, 959
    s_lshl_b32 s91, s91, 1
    s_mul_hi_u32 s90, s91, 0x1111112
    s_mul_i32 s94, s90, 240
    s_sub_u32 s91, s91, s94
    s_mul_i32 s94, s90, 440
    s_add_u32 s94, s94, s91
    s_lshl_b32 s94, s94, 10
    s_add_u32 s26, s94, 0x40000
    s_mul_hi_u32 s94, s91, 0x33333334
    s_mul_i32 s95, s94, 5
    s_sub_u32 s95, s91, s95
    s_mul_i32 s94, s94, 40960
    s_mul_i32 s96, s90, 160
    s_add_u32 s94, s94, s96
    s_lshl_b32 s95, s95, 5
    s_add_u32 s27, s94, s95
    s_add_u32 s91, s91, 1
    s_mul_hi_u32 s94, s91, 0x33333334
    s_mul_i32 s95, s94, 5
    s_sub_u32 s95, s91, s95
    s_mul_i32 s94, s94, 40960
    s_mul_i32 s96, s90, 160
    s_add_u32 s94, s94, s96
    s_lshl_b32 s95, s95, 5
    s_add_u32 s29, s94, s95
    v_lshrrev_b32 v85, 5, v0
    v_lshlrev_b32 v85, 4, v85
    v_bfe_u32 v86, v0, 4, 1
    v_lshl_add_u32 v85, v86, 2, v85
    v_bfe_u32 v86, v0, 2, 2
    v_add_u32 v85, v85, v86
    v_lshlrev_b32 v85, 5, v85
    v_and_b32 v86, 3, v0
    v_lshl_add_u32 v85, v86, 3, v85
    s_add_u32 s97, s99, 53248
    v_add_u32 v15, s97, v85
    s_add_u32 s97, s99, 73728
    v_and_b32 v85, 15, v0
    v_lshrrev_b32 v86, 4, v0
    v_lshrrev_b32 v87, 1, v85
    v_xor_b32 v86, v86, v87
    v_lshlrev_b32 v86, 4, v86
    v_xor_b32 v87, 64, v86
    v_and_b32 v89, 7, v85
    v_lshrrev_b32 v85, 3, v85
    v_lshlrev_b32 v85, 12, v85
    v_lshl_add_u32 v85, v89, 7, v85
    v_add_u32 v85, s97, v85
    v_add_u32 v62, v86, v85
    v_add_u32 v63, v87, v85
    s_cmp_lt_u32 s98, 800
    s_cselect_b32 s91, 0, 0x40000000
    v_add_u32 v60, s91, v60
    v_add_u32 v61, s91, v61
    v_add_u32 v2, s91, v14
    s_min_u32 s91, s98, 799
    s_cmp_ge_u32 s91, 400
    s_cselect_b32 s90, 1, 0
    s_cselect_b32 s60, s16, s14
    s_cselect_b32 s61, s17, s15
    s_and_b32 s61, s61, 0xffff
    s_mov_b32 s62, 819200
    s_mov_b32 s63, 0x20000
    s_mul_i32 s94, s90, 400
    s_sub_u32 s91, s91, s94
    s_mul_hi_u32 s94, s91, 0x51eb852
    s_mul_i32 s95, s94, 50
    s_sub_u32 s91, s91, s95
    s_mul_hi_u32 s95, s91, 0x33333334
    s_mul_i32 s96, s95, 5
    s_sub_u32 s96, s91, s96
    s_mul_i32 s97, s94, 80
    s_lshl_b32 s91, s96, 4
    s_add_u32 s97, s97, s91
    s_mul_i32 s97, s97, 1280
    s_lshl_b32 s91, s95, 7
    s_add_u32 s24, s97, s91
    s_mul_i32 s90, s90, 20
    s_lshl_b32 s95, s95, 1
    s_add_u32 s90, s90, s95
    s_add_u32 s90, s90, 48
    s_mul_i32 s94, s94, 88
    s_add_u32 s90, s90, s94
    s_mul_i32 s90, s90, 5
    s_add_u32 s90, s90, s96
    s_lshl_b32 s90, s90, 10
    s_add_u32 s25, s90, 0x40000
    s_add_u32 m0, s4, 8192
    s_nop 0
    buffer_load_dwordx4 v48, s[36:39], s78 offen lds
    s_add_u32 m0, s4, 9216
    s_nop 0
    buffer_load_dwordx4 v49, s[36:39], s78 offen lds
    s_add_u32 m0, s4, 10240
    s_nop 0
    buffer_load_dwordx4 v50, s[36:39], s78 offen lds
    s_add_u32 m0, s4, 11264
    s_nop 0
    buffer_load_dwordx4 v51, s[36:39], s78 offen lds
    s_add_u32 m0, s99, 8192
    s_nop 0
    buffer_load_dwordx4 v3, s[44:47], s78 offen lds
    s_add_u32 m0, s99, 28672
    s_nop 0
    buffer_load_dwordx4 v3, s[48:51], s78 offen lds
    s_add_u32 m0, s4, 12288
    s_nop 0
    buffer_load_dwordx4 v48, s[36:39], s79 offen lds
    s_add_u32 m0, s4, 13312
    s_nop 0
    buffer_load_dwordx4 v49, s[36:39], s79 offen lds
    s_add_u32 m0, s4, 14336
    s_nop 0
    buffer_load_dwordx4 v50, s[36:39], s79 offen lds
    s_add_u32 m0, s4, 15360
    s_nop 0
    buffer_load_dwordx4 v51, s[36:39], s79 offen lds
    s_add_u32 m0, s99, 12288
    s_nop 0
    buffer_load_dwordx4 v3, s[44:47], s79 offen lds
    s_add_u32 m0, s99, 32768
    s_nop 0
    buffer_load_dwordx4 v3, s[48:51], s79 offen lds
    s_waitcnt vmcnt(12)
    ds_read_b128 a[160:163], v11 offset:0
    ds_read_b128 a[164:167], v11 offset:16
    ds_read_b128 a[168:171], v11 offset:64
    ds_read_b128 a[172:175], v11 offset:80
    ds_read_b128 a[176:179], v11 offset:128
    ds_read_b128 a[180:183], v11 offset:144
    ds_read_b128 a[184:187], v11 offset:192
    ds_read_b128 a[188:191], v11 offset:208
    ds_read_b128 a[192:195], v11 offset:256
    ds_read_b128 a[196:199], v11 offset:272
    ds_read_b128 a[200:203], v11 offset:320
    ds_read_b128 a[204:207], v11 offset:336
    ds_read_b128 a[208:211], v11 offset:384
    ds_read_b128 a[212:215], v11 offset:400
    ds_read_b128 a[216:219], v11 offset:448
    ds_read_b128 a[220:223], v11 offset:464
    ds_read_b128 a[224:227], v11 offset:512
    ds_read_b128 a[228:231], v11 offset:528
    ds_read_b128 a[232:235], v11 offset:576
    ds_read_b128 a[236:239], v11 offset:592
    ds_read_b128 a[0:3], v52 offset:0
    ds_read_b128 a[4:7], v53 offset:0
    ds_read_b128 a[8:11], v54 offset:0
    ds_read_b128 a[12:15], v55 offset:0
    s_barrier
    ds_read_b128 v[96:99], v16 offset:0
    ds_read_b128 v[100:103], v16 offset:20480
    ds_read_b128 v[104:107], v17 offset:0
    ds_read_b128 v[108:111], v17 offset:20480
    ds_read_b128 v[112:115], v18 offset:0
    ds_read_b128 v[116:119], v18 offset:20480
    s_waitcnt lgkmcnt(0)
    v_mfma_f32_32x32x16_bf16 v[128:143], a[0:3], v[96:99], 0
    ds_read_b128 a[16:19], v52 offset:4096
    ds_read_b128 a[20:23], v53 offset:4096
    ds_read_b128 a[24:27], v54 offset:4096
    ds_read_b128 a[28:31], v55 offset:4096
    s_add_u32 m0, s4, 0
    s_nop 0
    buffer_load_dwordx4 v48, s[36:39], s80 offen lds
    s_add_u32 m0, s4, 1024
    s_nop 0
    buffer_load_dwordx4 v49, s[36:39], s80 offen lds
    v_mfma_f32_32x32x16_bf16 v[144:159], a[0:3], v[100:103], 0
    ds_read_b128 v[120:123], v19 offset:0
    ds_read_b128 v[124:127], v19 offset:20480
    v_mfma_f32_32x32x16_bf16 v[160:175], a[160:163], a[0:3], 0
    v_and_b32 v80, 31, v0
    v_lshrrev_b32 v81, 5, v0
    v_lshrrev_b32 v82, 4, v80
    v_mfma_f32_32x32x16_bf16 v[128:143], a[4:7], v[104:107], v[128:143]
    v_lshlrev_b32 v82, 10, v82
    v_and_b32 v83, 15, v80
    v_lshl_add_u32 v83, v81, 4, v83
    s_waitcnt lgkmcnt(2)
    s_add_u32 m0, s4, 4096
    s_nop 0
    buffer_load_dwordx4 v48, s[36:39], s81 offen lds
    s_add_u32 m0, s99, 16384
    s_nop 0
    buffer_load_dwordx4 v3, s[44:47], s80 offen lds
    s_add_u32 m0, s4, 2048
    s_nop 0
    buffer_load_dwordx4 v50, s[36:39], s80 offen lds
    s_add_u32 m0, s4, 3072
    s_nop 0
    buffer_load_dwordx4 v51, s[36:39], s80 offen lds
    ds_read_b128 a[160:163], v11 offset:640
    v_mfma_f32_32x32x16_bf16 v[144:159], a[4:7], v[108:111], v[144:159]
    v_lshl_add_u32 v5, v83, 4, v82
    v_lshlrev_b32 v6, 4, v80
    v_mul_u32_u24 v10, 80, v80
    s_barrier
    ds_read_b128 v[96:99], v16 offset:4096
    ds_read_b128 v[100:103], v16 offset:24576
    v_mfma_f32_32x32x16_bf16 v[160:175], a[164:167], a[4:7], v[160:175]
    v_add_u32 v10, 143360, v10
    s_lshl_b32 s95, s66, 1
    v_add_u32 v88, s95, v81
    v_mfma_f32_32x32x16_bf16 v[128:143], a[8:11], v[112:115], v[128:143]
    v_lshl_add_u32 v9, v88, 3, v10
    v_add_u32 v83, 0, v88
    v_sub_u32 v89, s67, v83
    s_add_u32 m0, s4, 5120
    s_nop 0
    buffer_load_dwordx4 v49, s[36:39], s81 offen lds
    s_add_u32 m0, s99, 53248
    s_nop 0
    buffer_load_dwordx4 v59, s[56:59], s27 offen lds
    ds_read_b128 a[164:167], v11 offset:656
    v_mfma_f32_32x32x16_bf16 v[144:159], a[8:11], v[116:119], v[144:159]
    v_add_u32 v89, -1, v89
    v_cmp_gt_u32 vcc, s67, v83
    s_nop 1
    v_cndmask_b32 v89, -1, v89, vcc
    v_cndmask_b32 v83, 0, v83, vcc
    ds_read_b128 v[104:107], v17 offset:4096
    ds_read_b128 v[108:111], v17 offset:24576
    v_mfma_f32_32x32x16_bf16 v[160:175], a[168:171], a[8:11], v[160:175]
    v_lshl_add_u32 v7, v83, 9, v6
    v_add_u32 v83, 8, v88
    s_waitcnt lgkmcnt(7)
    v_mfma_f32_32x32x16_bf16 v[128:143], a[12:15], v[120:123], v[128:143]
    v_sub_u32 v90, s67, v83
    v_add_u32 v90, -1, v90
    v_cmp_gt_u32 vcc, s67, v83
    s_nop 1
    v_cndmask_b32 v90, -1, v90, vcc
    v_cndmask_b32 v83, 0, v83, vcc
    s_add_u32 m0, s4, 6144
    s_nop 0
    buffer_load_dwordx4 v50, s[36:39], s81 offen lds
    s_add_u32 m0, s99, 36864
    s_nop 0
    buffer_load_dwordx4 v3, s[48:51], s80 offen lds
    s_add_u32 m0, s99, 57344
    s_nop 0
    buffer_load_dwordx4 v59, s[56:59], s29 offen lds
    ds_read_b128 a[168:171], v11 offset:704
    s_waitcnt lgkmcnt(7)
    v_mfma_f32_32x32x16_bf16 v[144:159], a[12:15], v[124:127], v[144:159]
    v_lshl_add_u32 v8, v83, 9, v6
    ds_read_b128 v[112:115], v18 offset:4096
    ds_read_b128 v[116:119], v18 offset:24576
    v_mfma_f32_32x32x16_bf16 v[160:175], a[172:175], a[12:15], v[160:175]
    v_and_b32 v84, 15, v0
    v_bfe_u32 v85, v0, 4, 1
    v_lshrrev_b32 v82, 2, v84
    s_waitcnt lgkmcnt(7)
    v_mfma_f32_32x32x16_bf16 v[128:143], a[16:19], v[96:99], v[128:143]
    v_lshl_add_u32 v82, v81, 4, v82
    v_lshlrev_b32 v82, 7, v82
    v_and_b32 v83, 1, v84
    s_add_u32 m0, s4, 7168
    s_nop 0
    buffer_load_dwordx4 v51, s[36:39], s81 offen lds
    s_waitcnt vmcnt(20)
    ds_read_b128 a[32:35], v52 offset:8192
    ds_read_b128 a[36:39], v53 offset:8192
    ds_read_b128 a[40:43], v54 offset:8192
    ds_read_b128 a[44:47], v55 offset:8192
    s_add_u32 m0, s99, 73728
    s_nop 0
    buffer_load_dwordx4 v60, s[60:63], s24 offen lds
    ds_read_b128 a[172:175], v11 offset:720
    s_waitcnt lgkmcnt(11)
    v_mfma_f32_32x32x16_bf16 v[144:159], a[16:19], v[100:103], v[144:159]
    v_lshl_add_u32 v82, v83, 3, v82
    v_bfe_u32 v83, v84, 1, 1
    v_lshl_add_u32 v83, v85, 1, v83
    ds_read_b128 v[120:123], v19 offset:4096
    ds_read_b128 v[124:127], v19 offset:24576
    v_mfma_f32_32x32x16_bf16 v[160:175], a[176:179], a[16:19], v[160:175]
    v_bfe_u32 v86, v84, 3, 1
    v_lshlrev_b32 v86, 2, v86
    v_xor_b32 v83, v83, v86
    s_waitcnt lgkmcnt(11)
    v_mfma_f32_32x32x16_bf16 v[128:143], a[20:23], v[104:107], v[128:143]
    v_xor_b32 v20, 0, v83
    v_lshl_add_u32 v20, v20, 4, v82
    v_add_u32 v22, 61440, v20
    s_waitcnt lgkmcnt(3)
    s_add_u32 m0, s4, 8192
    s_nop 0
    buffer_load_dwordx4 v48, s[36:39], s82 offen lds
    s_add_u32 m0, s99, 40960
    s_nop 0
    buffer_load_dwordx4 v3, s[44:47], s81 offen lds
    s_add_u32 m0, s99, 77824
    s_nop 0
    buffer_load_dwordx4 v61, s[60:63], s24 offen lds
    ds_read_b128 a[176:179], v11 offset:768
    v_mfma_f32_32x32x16_bf16 v[144:159], a[20:23], v[108:111], v[144:159]
    v_add_u32 v24, 122880, v20
    v_xor_b32 v21, 4, v83
    v_lshl_add_u32 v21, v21, 4, v82
    s_waitcnt vmcnt(22)
    s_barrier
    ds_read_b128 v[96:99], v16 offset:8192
    ds_read_b128 v[100:103], v16 offset:28672
    v_mfma_f32_32x32x16_bf16 v[160:175], a[180:183], a[20:23], v[160:175]
    v_add_u32 v23, 61440, v21
    v_add_u32 v25, 122880, v21
    s_lshr_b32 s90, s66, 1
    v_mfma_f32_32x32x16_bf16 v[128:143], a[24:27], v[112:115], v[128:143]
    s_lshl_b32 s91, s67, 1
    s_add_u32 s90, s90, s91
    s_mul_i32 s90, s90, 360448
    s_add_u32 m0, s4, 9216
    s_nop 0
    buffer_load_dwordx4 v49, s[36:39], s82 offen lds
    ds_read_b128 a[180:183], v11 offset:784
    v_mfma_f32_32x32x16_bf16 v[144:159], a[24:27], v[116:119], v[144:159]
    s_and_b32 s91, s66, 1
    s_lshl_b32 s91, s91, 11
    s_add_u32 s90, s90, s91
    ds_read_b128 v[104:107], v17 offset:8192
    ds_read_b128 v[108:111], v17 offset:28672
    v_mfma_f32_32x32x16_bf16 v[160:175], a[184:187], a[24:27], v[160:175]
    s_add_u32 s90, s90, 0x400000
    s_lshl_b32 s91, s69, 14
    s_add_u32 s22, s90, s91
    s_waitcnt lgkmcnt(7)
    v_mfma_f32_32x32x16_bf16 v[128:143], a[28:31], v[120:123], v[128:143]
    s_lshl_b32 s91, s68, 12
    s_add_u32 s23, s90, s91
    s_add_u32 s64, s3, 1
    s_add_u32 m0, s4, 10240
    s_nop 0
    buffer_load_dwordx4 v50, s[36:39], s82 offen lds
    s_add_u32 m0, s99, 61440
    s_nop 0
    buffer_load_dwordx4 v3, s[48:51], s81 offen lds
    ds_read_b128 a[184:187], v11 offset:832
    s_waitcnt lgkmcnt(7)
    v_mfma_f32_32x32x16_bf16 v[144:159], a[28:31], v[124:127], v[144:159]
    s_xor_b32 s65, s64, 0x5bd1e995
    v_lshlrev_b32 v80, 16, v26
    v_lshlrev_b32 v81, 16, v27
    ds_read_b128 v[112:115], v18 offset:8192
    ds_read_b128 v[116:119], v18 offset:28672
    v_mfma_f32_32x32x16_bf16 v[160:175], a[188:191], a[28:31], v[160:175]
    v_lshlrev_b32 v82, 16, v37
    v_mul_f32 v82, 0x3fb8aa3b, v82
    v_exp_f32 v82, v82
    s_waitcnt lgkmcnt(7)
    v_mfma_f32_32x32x16_bf16 v[128:143], a[32:35], v[96:99], v[128:143]
    v_cvt_pk_bf16_f32 v82, v82, v82
    v_lshlrev_b32 v82, 16, v82
    v_mul_f32 v83, v82, v80
    s_add_u32 m0, s4, 11264
    s_nop 0
    buffer_load_dwordx4 v51, s[36:39], s82 offen lds
    s_waitcnt vmcnt(22)
    ds_read_b128 a[48:51], v52 offset:12288
    ds_read_b128 a[52:55], v53 offset:12288
    ds_read_b128 a[56:59], v54 offset:12288
    ds_read_b128 a[60:63], v55 offset:12288
    ds_read_b128 a[188:191], v11 offset:848
    s_waitcnt lgkmcnt(11)
    v_mfma_f32_32x32x16_bf16 v[144:159], a[32:35], v[100:103], v[144:159]
    v_mul_f32 v84, v82, v81
    v_mul_f32 v83, 0x3fb8aa3b, v83
    v_mul_f32 v84, 0x3e22f983, v84
    ds_read_b128 v[120:123], v19 offset:8192
    ds_read_b128 v[124:127], v19 offset:28672
    v_mfma_f32_32x32x16_bf16 v[160:175], a[192:195], a[32:35], v[160:175]
    v_mul_f32 v82, 0x3f800000, v83
    v_mul_f32 v85, 0x3f800000, v84
    v_exp_f32 v82, v82
    s_waitcnt lgkmcnt(11)
    v_mfma_f32_32x32x16_bf16 v[128:143], a[36:39], v[104:107], v[128:143]
    v_fract_f32 v85, v85
    v_cos_f32 v26, v85
    v_sin_f32 v27, v85
    s_waitcnt lgkmcnt(3)
    s_add_u32 m0, s4, 12288
    s_nop 0
    buffer_load_dwordx4 v48, s[36:39], s83 offen lds
    s_add_u32 m0, s99, 45056
    s_nop 0
    buffer_load_dwordx4 v3, s[44:47], s82 offen lds
    ds_read_b128 a[192:195], v11 offset:896
    v_mfma_f32_32x32x16_bf16 v[144:159], a[36:39], v[108:111], v[144:159]
    v_mul_f32 v26, v82, v26
    v_mul_f32 v27, v82, v27
    v_sub_f32 v28, 0, v27
    s_waitcnt vmcnt(22)
    s_barrier
    ds_read_b128 v[96:99], v16 offset:12288
    ds_read_b128 v[100:103], v16 offset:32768
    v_mfma_f32_32x32x16_bf16 v[160:175], a[196:199], a[36:39], v[160:175]
    v_mul_f32 v82, 0x41800000, v83
    v_mul_f32 v85, 0x41800000, v84
    v_exp_f32 v82, v82
    v_mfma_f32_32x32x16_bf16 v[128:143], a[40:43], v[112:115], v[128:143]
    v_fract_f32 v85, v85
    v_cos_f32 v29, v85
    v_sin_f32 v30, v85
    s_add_u32 m0, s4, 13312
    s_nop 0
    buffer_load_dwordx4 v49, s[36:39], s83 offen lds
    ds_read_b128 a[196:199], v11 offset:912
    v_mfma_f32_32x32x16_bf16 v[144:159], a[40:43], v[116:119], v[144:159]
    v_mul_f32 v29, v82, v29
    v_mul_f32 v30, v82, v30
    v_cvt_f32_u32 v86, v88
    ds_read_b128 v[104:107], v17 offset:12288
    ds_read_b128 v[108:111], v17 offset:32768
    v_mfma_f32_32x32x16_bf16 v[160:175], a[200:203], a[40:43], v[160:175]
    v_mul_f32 v86, 0x41800000, v86
    v_mul_f32 v82, v86, v83
    v_mul_f32 v85, v86, v84
    s_waitcnt lgkmcnt(7)
    v_mfma_f32_32x32x16_bf16 v[128:143], a[44:47], v[120:123], v[128:143]
    s_waitcnt vmcnt(12)
    ds_read_b64_tr_b16 v[64:65], v15 offset:0
    v_exp_f32 v82, v82
    v_fract_f32 v85, v85
    s_add_u32 m0, s4, 14336
    s_nop 0
    buffer_load_dwordx4 v50, s[36:39], s83 offen lds
    s_add_u32 m0, s99, 65536
    s_nop 0
    buffer_load_dwordx4 v3, s[48:51], s82 offen lds
    ds_read_b128 a[200:203], v11 offset:960
    s_waitcnt lgkmcnt(8)
    v_mfma_f32_32x32x16_bf16 v[144:159], a[44:47], v[124:127], v[144:159]
    v_cos_f32 v31, v85
    v_sin_f32 v32, v85
    v_mul_f32 v31, v82, v31
    ds_read_b128 v[112:115], v18 offset:12288
    ds_read_b128 v[116:119], v18 offset:32768
    v_mfma_f32_32x32x16_bf16 v[160:175], a[204:207], a[44:47], v[160:175]
    ds_read_b64_tr_b16 v[66:67], v15 offset:256
    v_mul_f32 v32, v82, v32
    v_cvt_f32_i32 v86, v89
    s_waitcnt lgkmcnt(9)
    v_mfma_f32_32x32x16_bf16 v[128:143], a[48:51], v[96:99], v[128:143]
    v_mul_f32 v86, 0x43000000, v86
    v_mul_f32 v82, v86, v83
    v_mul_f32 v85, v86, v84
    s_add_u32 m0, s4, 15360
    s_nop 0
    buffer_load_dwordx4 v51, s[36:39], s83 offen lds
    ds_read_b128 a[64:67], v52 offset:0
    ds_read_b128 a[68:71], v53 offset:0
    ds_read_b128 a[72:75], v54 offset:0
    ds_read_b128 a[76:79], v55 offset:0
    ds_read_b128 a[204:207], v11 offset:976
    s_waitcnt lgkmcnt(13)
    v_mfma_f32_32x32x16_bf16 v[144:159], a[48:51], v[100:103], v[144:159]
    ds_read_b64_tr_b16 v[68:69], v15 offset:4096
    v_exp_f32 v82, v82
    v_fract_f32 v85, v85
    ds_read_b128 v[120:123], v19 offset:12288
    ds_read_b128 v[124:127], v19 offset:32768
    v_mfma_f32_32x32x16_bf16 v[160:175], a[208:211], a[48:51], v[160:175]
    v_cos_f32 v33, v85
    v_sin_f32 v34, v85
    v_mul_f32 v33, v82, v33
    s_waitcnt lgkmcnt(14)
    v_mfma_f32_32x32x16_bf16 v[128:143], a[52:55], v[104:107], v[128:143]
    ds_read_b64_tr_b16 v[70:71], v15 offset:4352
    v_mul_f32 v34, v82, v34
    v_cmp_le_i32 vcc, 0, v89
    s_nop 1
    v_cndmask_b32 v33, 0, v33, vcc
    v_cndmask_b32 v34, 0, v34, vcc
    s_waitcnt lgkmcnt(5)
    s_add_u32 m0, s4, 0
    s_nop 0
    buffer_load_dwordx4 v48, s[36:39], s84 offen lds
    s_add_u32 m0, s99, 49152
    s_nop 0
    buffer_load_dwordx4 v3, s[44:47], s83 offen lds
    ds_read_b128 a[208:211], v11 offset:1024
    v_mfma_f32_32x32x16_bf16 v[144:159], a[52:55], v[108:111], v[144:159]
    v_cvt_f32_i32 v86, v90
    s_barrier
    ds_read_b128 v[96:99], v16 offset:16384
    ds_read_b128 v[100:103], v16 offset:36864
    v_mfma_f32_32x32x16_bf16 v[160:175], a[212:215], a[52:55], v[160:175]
    s_waitcnt vmcnt(12)
    ds_read_b128 v[72:75], v62
    v_mul_f32 v86, 0x43000000, v86
    v_mul_f32 v82, v86, v83
    v_mfma_f32_32x32x16_bf16 v[128:143], a[56:59], v[112:115], v[128:143]
    v_mul_f32 v85, v86, v84
    v_exp_f32 v82, v82
    v_fract_f32 v85, v85
    s_add_u32 m0, s4, 1024
    s_nop 0
    buffer_load_dwordx4 v49, s[36:39], s84 offen lds
    ds_read_b128 a[212:215], v11 offset:1040
    v_mfma_f32_32x32x16_bf16 v[144:159], a[56:59], v[116:119], v[144:159]
    ds_read_b128 v[76:79], v63
    v_cos_f32 v35, v85
    v_sin_f32 v36, v85
    ds_read_b128 v[104:107], v17 offset:16384
    ds_read_b128 v[108:111], v17 offset:36864
    v_mfma_f32_32x32x16_bf16 v[160:175], a[216:219], a[56:59], v[160:175]
    v_mul_f32 v35, v82, v35
    v_mul_f32 v36, v82, v36
    v_cmp_le_i32 vcc, 0, v90
    s_nop 1
    v_cndmask_b32 v35, 0, v35, vcc
    v_cndmask_b32 v36, 0, v36, vcc
    s_waitcnt lgkmcnt(10)
    v_mfma_f32_32x32x16_bf16 v[128:143], a[60:63], v[120:123], v[128:143]
    v_add_f32 v82, -1.0, v26
    s_add_u32 m0, s4, 2048
    s_nop 0
    buffer_load_dwordx4 v50, s[36:39], s84 offen lds
    s_add_u32 m0, s99, 69632
    s_nop 0
    buffer_load_dwordx4 v3, s[48:51], s83 offen lds
    ds_read_b128 a[216:219], v11 offset:1088
    s_waitcnt lgkmcnt(10)
    v_mfma_f32_32x32x16_bf16 v[144:159], a[60:63], v[124:127], v[144:159]
    v_mul_f32 v83, v80, v80
    v_fmac_f32 v83, v81, v81
    v_rcp_f32 v83, v83
    ds_read_b128 v[112:115], v18 offset:16384
    ds_read_b128 v[116:119], v18 offset:36864
    v_mfma_f32_32x32x16_bf16 v[160:175], a[220:223], a[60:63], v[160:175]
    v_mul_f32 v84, v82, v80
    v_fmac_f32 v84, v27, v81
    v_mul_f32 v85, v27, v80
    s_waitcnt lgkmcnt(9)
    v_mfma_f32_32x32x16_bf16 v[128:143], a[64:67], v[96:99], v[128:143]
    v_fma_f32 v85, -v82, v81, v85
    v_add_f32 v83, v83, v83
    v_mul_f32 v37, v84, v83
    s_add_u32 m0, s4, 3072
    s_nop 0
    buffer_load_dwordx4 v51, s[36:39], s84 offen lds
    ds_read_b128 a[80:83], v52 offset:4096
    ds_read_b128 a[84:87], v53 offset:4096
    ds_read_b128 a[88:91], v54 offset:4096
    ds_read_b128 a[92:95], v55 offset:4096
    ds_read_b128 a[220:223], v11 offset:1104
    s_waitcnt lgkmcnt(13)
    v_mfma_f32_32x32x16_bf16 v[144:159], a[64:67], v[100:103], v[144:159]
    v_mul_f32 v38, v85, v83
    ds_read_b128 v[120:123], v19 offset:16384
    ds_read_b128 v[124:127], v19 offset:36864
    v_mfma_f32_32x32x16_bf16 v[160:175], a[224:227], a[64:67], v[160:175]
    s_waitcnt lgkmcnt(11)
    v_mfma_f32_32x32x16_bf16 v[128:143], a[68:71], v[104:107], v[128:143]
    s_waitcnt lgkmcnt(3)
    s_add_u32 m0, s4, 4096
    s_nop 0
    buffer_load_dwordx4 v48, s[36:39], s85 offen lds
    s_add_u32 m0, s99, 53248
    s_nop 0
    buffer_load_dwordx4 v3, s[44:47], s84 offen lds
    ds_read_b128 a[224:227], v11 offset:1152
    v_mfma_f32_32x32x16_bf16 v[144:159], a[68:71], v[108:111], v[144:159]
    s_waitcnt vmcnt(15)
    s_barrier
    ds_read_b128 v[96:99], v16 offset:40960
    ds_read_b128 v[100:103], v92 offset:0
    v_mfma_f32_32x32x16_bf16 v[160:175], a[228:231], a[68:71], v[160:175]
    v_mfma_f32_32x32x16_bf16 v[128:143], a[72:75], v[112:115], v[128:143]
    s_add_u32 m0, s4, 5120
    s_nop 0
    buffer_load_dwordx4 v49, s[36:39], s85 offen lds
    ds_read_b128 a[228:231], v11 offset:1168
    v_mfma_f32_32x32x16_bf16 v[144:159], a[72:75], v[116:119], v[144:159]
    ds_read_b128 v[104:107], v17 offset:40960
    ds_read_b128 v[108:111], v93 offset:0
    v_mfma_f32_32x32x16_bf16 v[160:175], a[232:235], a[72:75], v[160:175]
    s_waitcnt lgkmcnt(7)
    v_mfma_f32_32x32x16_bf16 v[128:143], a[76:79], v[120:123], v[128:143]
    s_add_u32 m0, s4, 6144
    s_nop 0
    buffer_load_dwordx4 v50, s[36:39], s85 offen lds
    s_add_u32 m0, s99, 73728
    s_nop 0
    buffer_load_dwordx4 v3, s[48:51], s84 offen lds
    ds_read_b128 a[232:235], v11 offset:1216
    s_waitcnt lgkmcnt(7)
    v_mfma_f32_32x32x16_bf16 v[144:159], a[76:79], v[124:127], v[144:159]
    ds_read_b128 v[112:115], v18 offset:40960
    ds_read_b128 v[116:119], v94 offset:0
    v_mfma_f32_32x32x16_bf16 v[160:175], a[236:239], a[76:79], v[160:175]
    s_waitcnt lgkmcnt(7)
    v_mfma_f32_32x32x16_bf16 v[128:143], a[80:83], v[96:99], v[128:143]
    s_add_u32 m0, s4, 7168
    s_nop 0
    buffer_load_dwordx4 v51, s[36:39], s85 offen lds
    s_waitcnt vmcnt(18)
    ds_read_b128 a[96:99], v52 offset:8192
    ds_read_b128 a[100:103], v53 offset:8192
    ds_read_b128 a[104:107], v54 offset:8192
    ds_read_b128 a[108:111], v55 offset:8192
    ds_read_b128 a[236:239], v11 offset:1232
    s_waitcnt lgkmcnt(11)
    v_mfma_f32_32x32x16_bf16 v[144:159], a[80:83], v[100:103], v[144:159]
    ds_read_b128 v[120:123], v19 offset:40960
    ds_read_b128 v[124:127], v95 offset:0
    v_mfma_f32_32x32x16_bf16 v[160:175], a[160:163], a[80:83], v[160:175]
    s_waitcnt lgkmcnt(11)
    v_mfma_f32_32x32x16_bf16 v[128:143], a[84:87], v[104:107], v[128:143]
    s_add_u32 m0, s99, 57344
    s_nop 0
    buffer_load_dwordx4 v3, s[44:47], s85 offen lds
    s_waitcnt lgkmcnt(10)
    v_mfma_f32_32x32x16_bf16 v[144:159], a[84:87], v[108:111], v[144:159]
    s_waitcnt vmcnt(14)
    s_barrier
    ds_read_b128 v[96:99], v16 offset:45056
    ds_read_b128 v[100:103], v92 offset:4096
    v_mfma_f32_32x32x16_bf16 v[160:175], a[164:167], a[84:87], v[160:175]
    s_waitcnt lgkmcnt(10)
    v_mfma_f32_32x32x16_bf16 v[128:143], a[88:91], v[112:115], v[128:143]
    s_add_u32 s92, s28, 0
    s_cmp_ge_u32 s92, 1966080
    s_cselect_b32 s93, 1966080, 0
    s_add_u32 m0, s99, 0
    s_sub_u32 s92, s92, s93
    buffer_load_dwordx4 v4, s[52:55], s92 offen lds
    s_add_u32 s92, s28, 98304
    s_cmp_ge_u32 s92, 1966080
    s_cselect_b32 s93, 1966080, 0
    s_add_u32 m0, s99, 4096
    s_sub_u32 s92, s92, s93
    buffer_load_dwordx4 v4, s[52:55], s92 offen lds
    s_waitcnt lgkmcnt(9)
    v_mfma_f32_32x32x16_bf16 v[144:159], a[88:91], v[116:119], v[144:159]
    ds_read_b128 v[104:107], v17 offset:45056
    ds_read_b128 v[108:111], v93 offset:4096
    v_mfma_f32_32x32x16_bf16 v[160:175], a[168:171], a[88:91], v[160:175]
    s_waitcnt lgkmcnt(5)
    v_mfma_f32_32x32x16_bf16 v[128:143], a[92:95], v[120:123], v[128:143]
    s_add_u32 m0, s99, 77824
    s_nop 0
    buffer_load_dwordx4 v3, s[48:51], s85 offen lds
    s_add_u32 s92, s28, 196608
    s_cmp_ge_u32 s92, 1966080
    s_cselect_b32 s93, 1966080, 0
    s_add_u32 m0, s99, 8192
    s_sub_u32 s92, s92, s93
    buffer_load_dwordx4 v4, s[52:55], s92 offen lds
    s_waitcnt lgkmcnt(4)
    v_mfma_f32_32x32x16_bf16 v[144:159], a[92:95], v[124:127], v[144:159]
    ds_read_b128 v[112:115], v18 offset:45056
    ds_read_b128 v[116:119], v94 offset:4096
    v_mfma_f32_32x32x16_bf16 v[160:175], a[172:175], a[92:95], v[160:175]
    s_waitcnt lgkmcnt(5)
    v_mfma_f32_32x32x16_bf16 v[128:143], a[96:99], v[96:99], v[128:143]
    s_waitcnt vmcnt(17)
    ds_read_b128 a[112:115], v52 offset:12288
    ds_read_b128 a[116:119], v53 offset:12288
    ds_read_b128 a[120:123], v54 offset:12288
    ds_read_b128 a[124:127], v55 offset:12288
    s_add_u32 s92, s28, 294912
    s_cmp_ge_u32 s92, 1966080
    s_cselect_b32 s93, 1966080, 0
    s_add_u32 m0, s99, 12288
    s_sub_u32 s92, s92, s93
    buffer_load_dwordx4 v4, s[52:55], s92 offen lds
    s_waitcnt lgkmcnt(8)
    v_mfma_f32_32x32x16_bf16 v[144:159], a[96:99], v[100:103], v[144:159]
    ds_read_b128 v[120:123], v19 offset:45056
    ds_read_b128 v[124:127], v95 offset:4096
    v_mfma_f32_32x32x16_bf16 v[160:175], a[176:179], a[96:99], v[160:175]
    s_waitcnt lgkmcnt(9)
    v_mfma_f32_32x32x16_bf16 v[128:143], a[100:103], v[104:107], v[128:143]
    s_waitcnt vmcnt(12)
    ds_read_b128 a[128:131], v52 offset:0
    ds_read_b128 a[132:135], v53 offset:0
    ds_read_b128 a[136:139], v54 offset:0
    ds_read_b128 a[140:143], v55 offset:0
    s_add_u32 s92, s28, 393216
    s_cmp_ge_u32 s92, 1966080
    s_cselect_b32 s93, 1966080, 0
    s_add_u32 m0, s99, 16384
    s_sub_u32 s92, s92, s93
    buffer_load_dwordx4 v4, s[52:55], s92 offen lds
    s_waitcnt lgkmcnt(12)
    v_mfma_f32_32x32x16_bf16 v[144:159], a[100:103], v[108:111], v[144:159]
    s_barrier
    ds_read_b128 v[96:99], v16 offset:49152
    ds_read_b128 v[100:103], v92 offset:8192
    v_mfma_f32_32x32x16_bf16 v[160:175], a[180:183], a[100:103], v[160:175]
    s_waitcnt lgkmcnt(13)
    v_mfma_f32_32x32x16_bf16 v[128:143], a[104:107], v[112:115], v[128:143]
    s_add_u32 s92, s28, 491520
    s_cmp_ge_u32 s92, 1966080
    s_cselect_b32 s93, 1966080, 0
    s_add_u32 m0, s99, 20480
    s_sub_u32 s92, s92, s93
    buffer_load_dwordx4 v4, s[52:55], s92 offen lds
    s_add_u32 s92, s28, 589824
    s_cmp_ge_u32 s92, 1966080
    s_cselect_b32 s93, 1966080, 0
    s_add_u32 m0, s99, 24576
    s_sub_u32 s92, s92, s93
    buffer_load_dwordx4 v4, s[52:55], s92 offen lds
    s_waitcnt lgkmcnt(12)
    v_mfma_f32_32x32x16_bf16 v[144:159], a[104:107], v[116:119], v[144:159]
    ds_read_b128 v[104:107], v17 offset:49152
    ds_read_b128 v[108:111], v93 offset:8192
    v_mfma_f32_32x32x16_bf16 v[160:175], a[184:187], a[104:107], v[160:175]
    s_waitcnt lgkmcnt(9)
    v_mfma_f32_32x32x16_bf16 v[128:143], a[108:111], v[120:123], v[128:143]
    s_waitcnt vmcnt(9)
    ds_read_b128 a[144:147], v52 offset:4096
    ds_read_b128 a[148:151], v53 offset:4096
    ds_read_b128 a[152:155], v54 offset:4096
    ds_read_b128 a[156:159], v55 offset:4096
    s_add_u32 s92, s28, 688128
    s_cmp_ge_u32 s92, 1966080
    s_cselect_b32 s93, 1966080, 0
    s_add_u32 m0, s99, 28672
    s_sub_u32 s92, s92, s93
    buffer_load_dwordx4 v4, s[52:55], s92 offen lds
    s_waitcnt lgkmcnt(12)
    v_mfma_f32_32x32x16_bf16 v[144:159], a[108:111], v[124:127], v[144:159]
    ds_read_b128 v[112:115], v18 offset:49152
    ds_read_b128 v[116:119], v94 offset:8192
    v_mfma_f32_32x32x16_bf16 v[160:175], a[188:191], a[108:111], v[160:175]
    s_waitcnt lgkmcnt(9)
    v_mfma_f32_32x32x16_bf16 v[128:143], a[112:115], v[96:99], v[128:143]
    s_add_u32 s92, s28, 786432
    s_cmp_ge_u32 s92, 1966080
    s_cselect_b32 s93, 1966080, 0
    s_add_u32 m0, s99, 32768
    s_sub_u32 s92, s92, s93
    buffer_load_dwordx4 v4, s[52:55], s92 offen lds
    s_add_u32 s92, s28, 884736
    s_cmp_ge_u32 s92, 1966080
    s_cselect_b32 s93, 1966080, 0
    s_add_u32 m0, s99, 36864
    s_sub_u32 s92, s92, s93
    buffer_load_dwordx4 v4, s[52:55], s92 offen lds
    s_waitcnt lgkmcnt(8)
    v_mfma_f32_32x32x16_bf16 v[144:159], a[112:115], v[100:103], v[144:159]
    ds_read_b128 v[120:123], v19 offset:49152
    ds_read_b128 v[124:127], v95 offset:8192
    v_mfma_f32_32x32x16_bf16 v[160:175], a[192:195], a[112:115], v[160:175]
    s_waitcnt lgkmcnt(9)
    v_mfma_f32_32x32x16_bf16 v[128:143], a[116:119], v[104:107], v[128:143]
    buffer_store_dwordx4 v[64:67], v1, s[40:43], s26 offen sc1
    buffer_store_dwordx4 v[68:71], v1, s[40:43], s26 offen offset:1024 sc1
    buffer_store_dwordx4 v[72:75], v2, s[40:43], s25 offen sc1
    s_add_u32 s96, s25, 5120
    buffer_store_dwordx4 v[76:79], v2, s[40:43], s96 offen sc1
    s_waitcnt lgkmcnt(8)
    v_mfma_f32_32x32x16_bf16 v[144:159], a[116:119], v[108:111], v[144:159]
    s_waitcnt lgkmcnt(4)
    s_barrier
    ds_read_b128 v[96:99], v16 offset:53248
    ds_read_b128 v[100:103], v92 offset:12288
    v_mfma_f32_32x32x16_bf16 v[160:175], a[196:199], a[116:119], v[160:175]
    s_waitcnt lgkmcnt(5)
    v_mfma_f32_32x32x16_bf16 v[128:143], a[120:123], v[112:115], v[128:143]
    s_add_u32 s92, s28, 983040
    s_cmp_ge_u32 s92, 1966080
    s_cselect_b32 s93, 1966080, 0
    s_add_u32 m0, s99, 81920
    s_sub_u32 s92, s92, s93
    buffer_load_dwordx4 v4, s[52:55], s92 offen lds
    s_waitcnt lgkmcnt(4)
    v_mfma_f32_32x32x16_bf16 v[144:159], a[120:123], v[116:119], v[144:159]
    ds_read_b128 v[104:107], v17 offset:53248
    ds_read_b128 v[108:111], v93 offset:12288
    v_mfma_f32_32x32x16_bf16 v[160:175], a[200:203], a[120:123], v[160:175]
    s_waitcnt lgkmcnt(5)
    v_mfma_f32_32x32x16_bf16 v[128:143], a[124:127], v[120:123], v[128:143]
    s_add_u32 s92, s28, 1081344
    s_cmp_ge_u32 s92, 1966080
    s_cselect_b32 s93, 1966080, 0
    s_add_u32 m0, s99, 86016
    s_sub_u32 s92, s92, s93
    buffer_load_dwordx4 v4, s[52:55], s92 offen lds
    s_waitcnt lgkmcnt(4)
    v_mfma_f32_32x32x16_bf16 v[144:159], a[124:127], v[124:127], v[144:159]
    ds_read_b128 v[112:115], v18 offset:53248
    ds_read_b128 v[116:119], v94 offset:12288
    v_mfma_f32_32x32x16_bf16 v[160:175], a[204:207], a[124:127], v[160:175]
    s_waitcnt lgkmcnt(5)
    v_mfma_f32_32x32x16_bf16 v[128:143], a[128:131], v[96:99], v[128:143]
    s_add_u32 s92, s28, 1179648
    s_cmp_ge_u32 s92, 1966080
    s_cselect_b32 s93, 1966080, 0
    s_add_u32 m0, s99, 90112
    s_sub_u32 s92, s92, s93
    buffer_load_dwordx4 v4, s[52:55], s92 offen lds
    s_waitcnt lgkmcnt(4)
    v_mfma_f32_32x32x16_bf16 v[144:159], a[128:131], v[100:103], v[144:159]
    ds_read_b128 v[120:123], v19 offset:53248
    ds_read_b128 v[124:127], v95 offset:12288
    v_mfma_f32_32x32x16_bf16 v[160:175], a[208:211], a[128:131], v[160:175]
    s_waitcnt lgkmcnt(5)
    v_mfma_f32_32x32x16_bf16 v[128:143], a[132:135], v[104:107], v[128:143]
    s_add_u32 s92, s28, 1277952
    s_cmp_ge_u32 s92, 1966080
    s_cselect_b32 s93, 1966080, 0
    s_add_u32 m0, s99, 94208
    s_sub_u32 s92, s92, s93
    buffer_load_dwordx4 v4, s[52:55], s92 offen lds
    s_waitcnt lgkmcnt(4)
    v_mfma_f32_32x32x16_bf16 v[144:159], a[132:135], v[108:111], v[144:159]
    s_waitcnt vmcnt(16)
    s_barrier
    ds_read_b128 v[96:99], v16 offset:57344
    ds_read_b128 v[100:103], v92 offset:16384
    v_mfma_f32_32x32x16_bf16 v[160:175], a[212:215], a[132:135], v[160:175]
    s_waitcnt lgkmcnt(5)
    v_mfma_f32_32x32x16_bf16 v[128:143], a[136:139], v[112:115], v[128:143]
    s_add_u32 s92, s28, 1376256
    s_cmp_ge_u32 s92, 1966080
    s_cselect_b32 s93, 1966080, 0
    s_add_u32 m0, s99, 98304
    s_sub_u32 s92, s92, s93
    buffer_load_dwordx4 v4, s[52:55], s92 offen lds
    s_waitcnt lgkmcnt(4)
    v_mfma_f32_32x32x16_bf16 v[144:159], a[136:139], v[116:119], v[144:159]
    ds_read_b128 v[104:107], v17 offset:57344
    ds_read_b128 v[108:111], v93 offset:16384
    v_mfma_f32_32x32x16_bf16 v[160:175], a[216:219], a[136:139], v[160:175]
    s_waitcnt lgkmcnt(5)
    v_mfma_f32_32x32x16_bf16 v[128:143], a[140:143], v[120:123], v[128:143]
    s_add_u32 s92, s28, 1474560
    s_cmp_ge_u32 s92, 1966080
    s_cselect_b32 s93, 1966080, 0
    s_add_u32 m0, s99, 102400
    s_sub_u32 s92, s92, s93
    buffer_load_dwordx4 v4, s[52:55], s92 offen lds
    s_waitcnt lgkmcnt(4)
    v_mfma_f32_32x32x16_bf16 v[144:159], a[140:143], v[124:127], v[144:159]
    ds_read_b128 v[112:115], v18 offset:57344
    ds_read_b128 v[116:119], v94 offset:16384
    v_mfma_f32_32x32x16_bf16 v[160:175], a[220:223], a[140:143], v[160:175]
    s_waitcnt lgkmcnt(5)
    v_mfma_f32_32x32x16_bf16 v[128:143], a[144:147], v[96:99], v[128:143]
    s_add_u32 s92, s28, 1572864
    s_cmp_ge_u32 s92, 1966080
    s_cselect_b32 s93, 1966080, 0
    s_add_u32 m0, s99, 106496
    s_sub_u32 s92, s92, s93
    buffer_load_dwordx4 v4, s[52:55], s92 offen lds
    s_waitcnt lgkmcnt(4)
    v_mfma_f32_32x32x16_bf16 v[144:159], a[144:147], v[100:103], v[144:159]
    ds_read_b128 v[120:123], v19 offset:57344
    ds_read_b128 v[124:127], v95 offset:16384
    v_mfma_f32_32x32x16_bf16 v[160:175], a[224:227], a[144:147], v[160:175]
    s_waitcnt lgkmcnt(5)
    v_mfma_f32_32x32x16_bf16 v[128:143], a[148:151], v[104:107], v[128:143]
    s_add_u32 s92, s28, 1671168
    s_cmp_ge_u32 s92, 1966080
    s_cselect_b32 s93, 1966080, 0
    s_add_u32 m0, s99, 110592
    s_sub_u32 s92, s92, s93
    buffer_load_dwordx4 v4, s[52:55], s92 offen lds
    s_waitcnt lgkmcnt(4)
    v_mfma_f32_32x32x16_bf16 v[144:159], a[148:151], v[108:111], v[144:159]
    v_mfma_f32_32x32x16_bf16 v[160:175], a[228:231], a[148:151], v[160:175]
    s_waitcnt lgkmcnt(3)
    v_mfma_f32_32x32x16_bf16 v[128:143], a[152:155], v[112:115], v[128:143]
    s_add_u32 s92, s28, 1769472
    s_cmp_ge_u32 s92, 1966080
    s_cselect_b32 s93, 1966080, 0
    s_add_u32 m0, s99, 114688
    s_sub_u32 s92, s92, s93
    buffer_load_dwordx4 v4, s[52:55], s92 offen lds
    s_waitcnt lgkmcnt(2)
    v_mfma_f32_32x32x16_bf16 v[144:159], a[152:155], v[116:119], v[144:159]
    v_mfma_f32_32x32x16_bf16 v[160:175], a[232:235], a[152:155], v[160:175]
    s_waitcnt lgkmcnt(1)
    v_mfma_f32_32x32x16_bf16 v[128:143], a[156:159], v[120:123], v[128:143]
    s_add_u32 s92, s28, 1867776
    s_cmp_ge_u32 s92, 1966080
    s_cselect_b32 s93, 1966080, 0
    s_add_u32 m0, s99, 118784
    s_sub_u32 s92, s92, s93
    buffer_load_dwordx4 v4, s[52:55], s92 offen lds
    s_waitcnt lgkmcnt(0)
    v_mfma_f32_32x32x16_bf16 v[144:159], a[156:159], v[124:127], v[144:159]
    v_mfma_f32_32x32x16_bf16 v[160:175], a[236:239], a[156:159], v[160:175]
    v_lshrrev_b32 v84, 5, v0
    s_lshl_b32 s95, s66, 1
    v_add_u32 v84, s95, v84
    v_cmp_eq_u32 s[76:77], 1, v84
    v_cmp_eq_u32 s[78:79], 2, v84
    v_cmp_eq_u32 s[80:81], 3, v84
    v_cmp_eq_u32 s[82:83], 4, v84
    v_cmp_eq_u32 s[84:85], 5, v84
    v_cmp_eq_u32 s[86:87], 6, v84
    v_cmp_eq_u32 s[88:89], 7, v84
    s_nop 1
    v_cvt_pk_bf16_f32 v72, v160, v160
    v_lshlrev_b32 v72, 16, v72
    v_mul_f32 v72, 0xbfb8aa3b, v72
    s_waitcnt vmcnt(14)
    s_barrier
    ds_read_b64_tr_b16 v[96:97], v20 offset:0
    ds_read_b64_tr_b16 v[98:99], v20 offset:512
    ds_read_b64_tr_b16 v[100:101], v20 offset:1024
    ds_read_b64_tr_b16 v[102:103], v20 offset:1536
    ds_read_b64_tr_b16 v[104:105], v20 offset:4096
    ds_read_b64_tr_b16 v[106:107], v20 offset:4608
    ds_read_b64_tr_b16 v[108:109], v20 offset:5120
    ds_read_b64_tr_b16 v[110:111], v20 offset:5632
    ds_read_b64_tr_b16 v[112:113], v20 offset:8192
    ds_read_b64_tr_b16 v[114:115], v20 offset:8704
    s_waitcnt lgkmcnt(8)
    v_mfma_f32_32x32x16_bf16 v[160:175], v[96:99], a[0:3], 0
    v_fma_f32 v48, v26, v128, v129
    v_fma_f32 v49, v26, v144, v145
    v_fmac_f32 v48, v28, v144
    v_fmac_f32 v49, v27, v128
    v_add_u32 v15, 4096, v14
    s_mul_i32 s24, s71, 450560
    s_add_u32 s24, s24, 0x40000
    ds_read_b64_tr_b16 v[116:117], v20 offset:9216
    ds_read_b64_tr_b16 v[118:119], v20 offset:9728
    s_waitcnt lgkmcnt(8)
    v_mfma_f32_32x32x16_bf16 v[160:175], v[100:103], a[4:7], v[160:175]
    s_add_u32 s92, s28, 128
    s_cmp_ge_u32 s92, 1966080
    s_cselect_b32 s93, 1966080, 0
    s_add_u32 m0, s99, 122880
    s_sub_u32 s92, s92, s93
    buffer_load_dwordx4 v4, s[52:55], s92 offen lds
    v_fma_f32 v50, v26, v48, v130
    v_fma_f32 v51, v26, v49, v146
    v_fmac_f32 v50, v28, v49
    s_mul_i32 s25, s70, 360448
    s_add_u32 s25, s25, 0x400000
    s_mul_i32 s34, s66, 10
    ds_read_b64_tr_b16 v[120:121], v20 offset:12288
    ds_read_b64_tr_b16 v[122:123], v20 offset:12800
    s_waitcnt lgkmcnt(8)
    v_mfma_f32_32x32x16_bf16 v[160:175], v[104:107], a[8:11], v[160:175]
    v_fmac_f32 v51, v27, v48
    v_fma_f32 v48, v26, v50, v131
    v_fma_f32 v49, v26, v51, v147
    v_fmac_f32 v48, v28, v51
    s_add_u32 s34, s34, 48
    s_mul_i32 s35, s66, 12
    s_sub_u32 s35, s35, 10
    ds_read_b64_tr_b16 v[124:125], v20 offset:13312
    ds_read_b64_tr_b16 v[126:127], v20 offset:13824
    s_waitcnt lgkmcnt(8)
    v_mfma_f32_32x32x16_bf16 v[160:175], v[108:111], a[12:15], v[160:175]
    s_add_u32 s92, s28, 98432
    s_cmp_ge_u32 s92, 1966080
    s_cselect_b32 s93, 1966080, 0
    s_add_u32 m0, s99, 126976
    s_sub_u32 s92, s92, s93
    buffer_load_dwordx4 v4, s[52:55], s92 offen lds
    v_fmac_f32 v49, v27, v50
    v_fma_f32 v50, v26, v48, v132
    s_mov_b32 s96, 0
    ds_read_b64_tr_b16 v[96:97], v20 offset:16384
    ds_read_b64_tr_b16 v[98:99], v20 offset:16896
    s_waitcnt lgkmcnt(8)
    v_mfma_f32_32x32x16_bf16 v[160:175], v[112:115], a[16:19], v[160:175]
    s_waitcnt vmcnt(12)
    v_mov_b32 v76, s64
    v_mov_b32 v77, s65
    v_mov_b32 v78, 0
    s_lshl_b32 s90, s98, 3
    s_add_u32 s90, s90, 0x4000
    buffer_store_dwordx2 v[76:77], v78, s[40:43], s90 offen sc1
    ds_read_b64_tr_b16 v[100:101], v20 offset:17408
    ds_read_b64_tr_b16 v[102:103], v20 offset:17920
    s_waitcnt lgkmcnt(8)
    v_mfma_f32_32x32x16_bf16 v[160:175], v[116:119], a[20:23], v[160:175]
    s_add_u32 s92, s28, 196736
    s_cmp_ge_u32 s92, 1966080
    s_cselect_b32 s93, 1966080, 0
    s_add_u32 m0, s99, 131072
    s_sub_u32 s92, s92, s93
    buffer_load_dwordx4 v4, s[52:55], s92 offen lds
    v_fma_f32 v51, v26, v49, v148
    v_fmac_f32 v50, v28, v49
    v_fmac_f32 v51, v27, v48
    ds_read_b64_tr_b16 v[104:105], v20 offset:20480
    ds_read_b64_tr_b16 v[106:107], v20 offset:20992
    s_waitcnt lgkmcnt(8)
    v_mfma_f32_32x32x16_bf16 v[160:175], v[120:123], a[24:27], v[160:175]
    v_fma_f32 v48, v26, v50, v133
    v_fma_f32 v49, v26, v51, v149
    v_fmac_f32 v48, v28, v51
    v_fmac_f32 v49, v27, v50
    s_cmp_ge_u32 s96, 22
    s_cselect_b32 s95, 22, 0
    s_sub_u32 s96, s96, s95
    ds_read_b64_tr_b16 v[108:109], v20 offset:21504
    ds_read_b64_tr_b16 v[110:111], v20 offset:22016
    s_waitcnt lgkmcnt(8)
    v_mfma_f32_32x32x16_bf16 v[160:175], v[124:127], a[28:31], v[160:175]
    s_add_u32 s92, s28, 295040
    s_cmp_ge_u32 s92, 1966080
    s_cselect_b32 s93, 1966080, 0
    s_add_u32 m0, s99, 135168
    s_sub_u32 s92, s92, s93
    buffer_load_dwordx4 v4, s[52:55], s92 offen lds
    v_fma_f32 v50, v26, v48, v134
    v_fma_f32 v51, v26, v49, v150
    v_fmac_f32 v50, v28, v49
    ds_read_b64_tr_b16 v[112:113], v20 offset:24576
    ds_read_b64_tr_b16 v[114:115], v20 offset:25088
    s_waitcnt lgkmcnt(8)
    v_mfma_f32_32x32x16_bf16 v[160:175], v[96:99], a[32:35], v[160:175]
    v_fmac_f32 v51, v27, v48
    v_fma_f32 v48, v26, v50, v135
    v_fma_f32 v49, v26, v51, v151
    v_fmac_f32 v48, v28, v51
    s_cmp_ge_u32 s96, 22
    s_cselect_b32 s95, 22, 0
    s_sub_u32 s96, s96, s95
    ds_read_b64_tr_b16 v[116:117], v20 offset:25600
    ds_read_b64_tr_b16 v[118:119], v20 offset:26112
    s_waitcnt lgkmcnt(8)
    v_mfma_f32_32x32x16_bf16 v[160:175], v[100:103], a[36:39], v[160:175]
    s_add_u32 s92, s28, 393344
    s_cmp_ge_u32 s92, 1966080
    s_cselect_b32 s93, 1966080, 0
    s_add_u32 m0, s99, 139264
    s_sub_u32 s92, s92, s93
    buffer_load_dwordx4 v4, s[52:55], s92 offen lds
    v_fmac_f32 v49, v27, v50
    v_fma_f32 v50, v26, v48, v136
    v_fma_f32 v51, v26, v49, v152
    ds_read_b64_tr_b16 v[120:121], v20 offset:28672
    ds_read_b64_tr_b16 v[122:123], v20 offset:29184
    s_waitcnt lgkmcnt(8)
    v_mfma_f32_32x32x16_bf16 v[160:175], v[104:107], a[40:43], v[160:175]
    v_fmac_f32 v50, v28, v49
    v_fmac_f32 v51, v27, v48
    v_fma_f32 v48, v26, v50, v137
    v_fma_f32 v49, v26, v51, v153
    s_cmp_lt_u32 s96, 10
    s_cselect_b32 s95, s34, s35
    s_add_u32 s4, s95, s96
    s_add_u32 s96, s96, 1
    s_cmp_eq_u32 s96, 22
    s_cselect_b32 s96, 0, s96
    ds_read_b64_tr_b16 v[124:125], v20 offset:29696
    ds_read_b64_tr_b16 v[126:127], v20 offset:30208
    s_waitcnt lgkmcnt(8)
    v_mfma_f32_32x32x16_bf16 v[160:175], v[108:111], a[44:47], v[160:175]
    s_add_u32 s92, s28, 491648
    s_cmp_ge_u32 s92, 1966080
    s_cselect_b32 s93, 1966080, 0
    s_add_u32 m0, s99, 40960
    s_sub_u32 s92, s92, s93
    buffer_load_dwordx4 v4, s[52:55], s92 offen lds
    v_fmac_f32 v48, v28, v51
    v_fmac_f32 v49, v27, v50
    ds_read_b64_tr_b16 v[96:97], v20 offset:32768
    ds_read_b64_tr_b16 v[98:99], v20 offset:33280
    s_waitcnt lgkmcnt(8)
    v_mfma_f32_32x32x16_bf16 v[160:175], v[112:115], a[48:51], v[160:175]
    v_fma_f32 v50, v26, v48, v138
    v_fma_f32 v51, v26, v49, v154
    v_fmac_f32 v50, v28, v49
    v_fmac_f32 v51, v27, v48
    s_cmp_lt_u32 s96, 10
    s_cselect_b32 s95, s34, s35
    s_add_u32 s5, s95, s96
    s_add_u32 s96, s96, 1
    s_cmp_eq_u32 s96, 22
    s_cselect_b32 s96, 0, s96
    ds_read_b64_tr_b16 v[100:101], v20 offset:33792
    ds_read_b64_tr_b16 v[102:103], v20 offset:34304
    s_waitcnt lgkmcnt(8)
    v_mfma_f32_32x32x16_bf16 v[160:175], v[116:119], a[52:55], v[160:175]
    s_add_u32 s92, s28, 589952
    s_cmp_ge_u32 s92, 1966080
    s_cselect_b32 s93, 1966080, 0
    s_add_u32 m0, s99, 45056
    s_sub_u32 s92, s92, s93
    buffer_load_dwordx4 v4, s[52:55], s92 offen lds
    v_fma_f32 v48, v26, v50, v139
    v_fma_f32 v49, v26, v51, v155
    ds_read_b64_tr_b16 v[104:105], v20 offset:36864
    ds_read_b64_tr_b16 v[106:107], v20 offset:37376
    s_waitcnt lgkmcnt(8)
    v_mfma_f32_32x32x16_bf16 v[160:175], v[120:123], a[56:59], v[160:175]
    v_fmac_f32 v48, v28, v51
    v_fmac_f32 v49, v27, v50
    v_fma_f32 v50, v26, v48, v140
    v_fma_f32 v51, v26, v49, v156
    s_cmp_lt_u32 s96, 10
    s_cselect_b32 s95, s34, s35
    s_add_u32 s6, s95, s96
    s_add_u32 s96, s96, 1
    s_cmp_eq_u32 s96, 22
    s_cselect_b32 s96, 0, s96
    ds_read_b64_tr_b16 v[108:109], v20 offset:37888
    ds_read_b64_tr_b16 v[110:111], v20 offset:38400
    s_waitcnt lgkmcnt(8)
    v_mfma_f32_32x32x16_bf16 v[160:175], v[124:127], a[60:63], v[160:175]
    s_add_u32 s92, s28, 688256
    s_cmp_ge_u32 s92, 1966080
    s_cselect_b32 s93, 1966080, 0
    s_add_u32 m0, s99, 49152
    s_sub_u32 s92, s92, s93
    buffer_load_dwordx4 v4, s[52:55], s92 offen lds
    v_fmac_f32 v50, v28, v49
    v_fmac_f32 v51, v27, v48
    v_fma_f32 v48, v26, v50, v141
    v_fma_f32 v49, v26, v51, v157
    v_fmac_f32 v48, v28, v51
    v_fmac_f32 v49, v27, v50
    v_fma_f32 v50, v26, v48, v142
    v_fma_f32 v51, v26, v49, v158
    v_fmac_f32 v50, v28, v49
    v_fmac_f32 v51, v27, v48
    v_fma_f32 v48, v26, v50, v143
    v_fma_f32 v49, v26, v51, v159
    v_fmac_f32 v48, v28, v51
    v_fmac_f32 v49, v27, v50
    ds_write_b64 v9, v[48:49] offset:14848
    s_waitcnt vmcnt(14)
    s_waitcnt lgkmcnt(0)
    s_barrier
    ds_read_b64_tr_b16 v[112:113], v22 offset:20480
    ds_read_b64_tr_b16 v[114:115], v22 offset:20992
    v_mfma_f32_32x32x16_bf16 v[160:175], v[96:99], a[64:67], v[160:175]
    ds_read_b128 v[56:59], v10 offset:14848
    ds_read_b128 v[60:63], v10 offset:14864
    ds_read_b128 v[64:67], v10 offset:14880
    ds_read_b128 v[68:71], v10 offset:14896
    ds_read_b64_tr_b16 v[116:117], v22 offset:21504
    ds_read_b64_tr_b16 v[118:119], v22 offset:22016
    v_mfma_f32_32x32x16_bf16 v[160:175], v[100:103], a[68:71], v[160:175]
    v_mov_b32 v48, 0
    v_mov_b32 v49, 0
    s_waitcnt lgkmcnt(5)
    v_fmac_f32 v58, v29, v56
    v_fmac_f32 v59, v29, v57
    ds_read_b64_tr_b16 v[120:121], v22 offset:24576
    ds_read_b64_tr_b16 v[122:123], v22 offset:25088
    v_mfma_f32_32x32x16_bf16 v[160:175], v[104:107], a[72:75], v[160:175]
    v_fma_f32 v58, -v30, v57, v58
    v_fmac_f32 v59, v30, v56
    s_waitcnt lgkmcnt(6)
    v_fmac_f32 v60, v29, v58
    v_fmac_f32 v61, v29, v59
    ds_read_b64_tr_b16 v[124:125], v22 offset:25600
    ds_read_b64_tr_b16 v[126:127], v22 offset:26112
    v_mfma_f32_32x32x16_bf16 v[160:175], v[108:111], a[76:79], v[160:175]
    v_fma_f32 v60, -v30, v59, v60
    v_fmac_f32 v61, v30, v58
    v_fmac_f32 v62, v29, v60
    v_fmac_f32 v63, v29, v61
    ds_read_b64_tr_b16 v[96:97], v22 offset:28672
    ds_read_b64_tr_b16 v[98:99], v22 offset:29184
    v_mfma_f32_32x32x16_bf16 v[160:175], v[112:115], a[80:83], v[160:175]
    v_fma_f32 v62, -v30, v61, v62
    v_fmac_f32 v63, v30, v60
    s_waitcnt lgkmcnt(9)
    v_fmac_f32 v64, v29, v62
    v_fmac_f32 v65, v29, v63
    ds_read_b64_tr_b16 v[100:101], v22 offset:29696
    ds_read_b64_tr_b16 v[102:103], v22 offset:30208
    s_waitcnt lgkmcnt(8)
    v_mfma_f32_32x32x16_bf16 v[160:175], v[116:119], a[84:87], v[160:175]
    v_fma_f32 v64, -v30, v63, v64
    v_fmac_f32 v65, v30, v62
    v_fmac_f32 v66, v29, v64
    v_fmac_f32 v67, v29, v65
    ds_read_b64_tr_b16 v[104:105], v22 offset:32768
    ds_read_b64_tr_b16 v[106:107], v22 offset:33280
    s_waitcnt lgkmcnt(8)
    v_mfma_f32_32x32x16_bf16 v[160:175], v[120:123], a[88:91], v[160:175]
    v_fma_f32 v66, -v30, v65, v66
    v_fmac_f32 v67, v30, v64
    v_fmac_f32 v68, v29, v66
    v_fmac_f32 v69, v29, v67
    ds_read_b64_tr_b16 v[108:109], v22 offset:33792
    ds_read_b64_tr_b16 v[110:111], v22 offset:34304
    s_waitcnt lgkmcnt(8)
    v_mfma_f32_32x32x16_bf16 v[160:175], v[124:127], a[92:95], v[160:175]
    v_fma_f32 v68, -v30, v67, v68
    v_fmac_f32 v69, v30, v66
    v_fmac_f32 v70, v29, v68
    v_fmac_f32 v71, v29, v69
    ds_read_b64_tr_b16 v[112:113], v22 offset:36864
    ds_read_b64_tr_b16 v[114:115], v22 offset:37376
    s_waitcnt lgkmcnt(8)
    v_mfma_f32_32x32x16_bf16 v[160:175], v[96:99], a[96:99], v[160:175]
    v_fma_f32 v70, -v30, v69, v70
    v_fmac_f32 v71, v30, v68
    v_mov_b32 v52, v70
    v_mov_b32 v53, s64
    ds_read_b64_tr_b16 v[116:117], v22 offset:37888
    ds_read_b64_tr_b16 v[118:119], v22 offset:38400
    s_waitcnt lgkmcnt(8)
    v_mfma_f32_32x32x16_bf16 v[160:175], v[100:103], a[100:103], v[160:175]
    v_mov_b32 v54, v71
    v_mov_b32 v55, s64
    s_add_u32 s97, s68, 0
    s_lshl_b32 s97, s97, 4
    s_cmp_lt_u32 s96, 10
    s_cselect_b32 s95, s34, s35
    s_add_u32 s7, s95, s96
    s_add_u32 s96, s96, 1
    s_cmp_eq_u32 s96, 22
    s_cselect_b32 s96, 0, s96
    s_waitcnt vmcnt(9)
    s_barrier
    ds_read_b64_tr_b16 v[120:121], v22 offset:40960
    ds_read_b64_tr_b16 v[122:123], v22 offset:41472
    s_waitcnt lgkmcnt(8)
    v_mfma_f32_32x32x16_bf16 v[160:175], v[104:107], a[104:107], v[160:175]
    s_add_u32 s97, s97, s67
    s_lshl_b32 s97, s97, 9
    s_add_u32 s97, s97, 0x10000
    buffer_store_dwordx4 v[52:55], v6, s[40:43], s97 offen sc1
    v_exp_f32 v72, v72
    v_and_b32 v73, 31, v0
    v_add_f32 v72, 1.0, v72
    ds_read_b64_tr_b16 v[124:125], v22 offset:41984
    ds_read_b64_tr_b16 v[126:127], v22 offset:42496
    s_waitcnt lgkmcnt(8)
    v_mfma_f32_32x32x16_bf16 v[160:175], v[108:111], a[108:111], v[160:175]
    v_cndmask_b32 v48, v48, v56, s[76:77]
    v_cndmask_b32 v49, v49, v57, s[76:77]
    v_cndmask_b32 v48, v48, v58, s[78:79]
    v_cndmask_b32 v49, v49, v59, s[78:79]
    ds_read_b64_tr_b16 v[96:97], v22 offset:45056
    ds_read_b64_tr_b16 v[98:99], v22 offset:45568
    s_waitcnt lgkmcnt(8)
    v_mfma_f32_32x32x16_bf16 v[160:175], v[112:115], a[112:115], v[160:175]
    v_cndmask_b32 v48, v48, v60, s[80:81]
    v_cndmask_b32 v49, v49, v61, s[80:81]
    v_cndmask_b32 v48, v48, v62, s[82:83]
    v_cndmask_b32 v49, v49, v63, s[82:83]
    ds_read_b64_tr_b16 v[100:101], v22 offset:46080
    ds_read_b64_tr_b16 v[102:103], v22 offset:46592
    s_waitcnt lgkmcnt(8)
    v_mfma_f32_32x32x16_bf16 v[160:175], v[116:119], a[116:119], v[160:175]
    v_cndmask_b32 v48, v48, v64, s[84:85]
    v_cndmask_b32 v49, v49, v65, s[84:85]
    v_cndmask_b32 v48, v48, v66, s[86:87]
    v_cndmask_b32 v49, v49, v67, s[86:87]
    ds_read_b64_tr_b16 v[104:105], v22 offset:49152
    ds_read_b64_tr_b16 v[106:107], v22 offset:49664
    s_waitcnt lgkmcnt(8)
    v_mfma_f32_32x32x16_bf16 v[160:175], v[120:123], a[120:123], v[160:175]
    v_cndmask_b32 v48, v48, v68, s[88:89]
    v_cndmask_b32 v49, v49, v69, s[88:89]
    v_rcp_f32 v72, v72
    v_bfe_u32 v74, v73, 2, 1
    ds_read_b64_tr_b16 v[108:109], v22 offset:50176
    ds_read_b64_tr_b16 v[110:111], v22 offset:50688
    s_waitcnt lgkmcnt(8)
    v_mfma_f32_32x32x16_bf16 v[160:175], v[124:127], a[124:127], v[160:175]
    v_cvt_pk_bf16_f32 v72, v72, v72
    v_lshlrev_b32 v12, 16, v72
    v_sub_f32 v72, 1.0, v12
    s_cmp_lt_u32 s96, 10
    s_cselect_b32 s95, s34, s35
    s_add_u32 s8, s95, s96
    s_add_u32 s96, s96, 1
    s_cmp_eq_u32 s96, 22
    s_cselect_b32 s96, 0, s96
    ds_read_b64_tr_b16 v[112:113], v22 offset:53248
    ds_read_b64_tr_b16 v[114:115], v22 offset:53760
    s_waitcnt lgkmcnt(8)
    v_mfma_f32_32x32x16_bf16 v[160:175], v[96:99], a[128:131], v[160:175]
    v_cvt_pk_bf16_f32 v72, v72, v72
    v_lshlrev_b32 v13, 16, v72
    v_lshlrev_b32 v74, 4, v74
    ds_read_b64_tr_b16 v[116:117], v22 offset:54272
    ds_read_b64_tr_b16 v[118:119], v22 offset:54784
    s_waitcnt lgkmcnt(8)
    v_mfma_f32_32x32x16_bf16 v[160:175], v[100:103], a[132:135], v[160:175]
    v_and_b32 v72, 3, v73
    v_add_u32 v72, v72, v74
    v_lshrrev_b32 v74, 3, v73
    s_cmp_lt_u32 s96, 10
    s_cselect_b32 s95, s34, s35
    s_add_u32 s9, s95, s96
    s_add_u32 s96, s96, 1
    s_cmp_eq_u32 s96, 22
    s_cselect_b32 s96, 0, s96
    ds_read_b64_tr_b16 v[120:121], v22 offset:57344
    ds_read_b64_tr_b16 v[122:123], v22 offset:57856
    s_waitcnt lgkmcnt(8)
    v_mfma_f32_32x32x16_bf16 v[160:175], v[104:107], a[136:139], v[160:175]
    v_lshl_add_u32 v72, v74, 2, v72
    s_lshl_b32 s95, s66, 5
    v_add_u32 v72, s95, v72
    s_add_u32 s92, s28, 786560
    s_cmp_ge_u32 s92, 1966080
    s_cselect_b32 s93, 1966080, 0
    s_add_u32 m0, s99, 53248
    s_sub_u32 s92, s92, s93
    buffer_load_dwordx4 v4, s[52:55], s92 offen lds
    ds_read_b64_tr_b16 v[124:125], v22 offset:58368
    ds_read_b64_tr_b16 v[126:127], v22 offset:58880
    s_waitcnt lgkmcnt(8)
    v_mfma_f32_32x32x16_bf16 v[160:175], v[108:111], a[140:143], v[160:175]
    v_lshlrev_b32 v72, 2, v72
    v_add_u32 v72, 149504, v72
    ds_write_b32 v72, v12
    ds_read_b64_tr_b16 v[96:97], v21 offset:0
    ds_read_b64_tr_b16 v[98:99], v21 offset:512
    s_waitcnt lgkmcnt(9)
    v_mfma_f32_32x32x16_bf16 v[160:175], v[112:115], a[144:147], v[160:175]
    s_add_u32 s92, s28, 884864
    s_cmp_ge_u32 s92, 1966080
    s_cselect_b32 s93, 1966080, 0
    s_add_u32 m0, s99, 57344
    s_sub_u32 s92, s92, s93
    buffer_load_dwordx4 v4, s[52:55], s92 offen lds
    s_cmp_lt_u32 s96, 10
    s_cselect_b32 s95, s34, s35
    s_add_u32 s10, s95, s96
    s_add_u32 s96, s96, 1
    s_cmp_eq_u32 s96, 22
    s_cselect_b32 s96, 0, s96
    ds_read_b64_tr_b16 v[100:101], v21 offset:1024
    ds_read_b64_tr_b16 v[102:103], v21 offset:1536
    s_waitcnt lgkmcnt(9)
    v_mfma_f32_32x32x16_bf16 v[160:175], v[116:119], a[148:151], v[160:175]
    s_cmp_lt_u32 s96, 10
    s_cselect_b32 s95, s34, s35
    s_add_u32 s11, s95, s96
    s_add_u32 s96, s96, 1
    s_cmp_eq_u32 s96, 22
    s_cselect_b32 s96, 0, s96
    ds_read_b64_tr_b16 v[104:105], v21 offset:4096
    ds_read_b64_tr_b16 v[106:107], v21 offset:4608
    s_waitcnt lgkmcnt(9)
    v_mfma_f32_32x32x16_bf16 v[160:175], v[120:123], a[152:155], v[160:175]
    s_add_u32 s92, s28, 983168
    s_cmp_ge_u32 s92, 1966080
    s_cselect_b32 s93, 1966080, 0
    s_add_u32 m0, s99, 61440
    s_sub_u32 s92, s92, s93
    buffer_load_dwordx4 v4, s[52:55], s92 offen lds
    s_cmp_lt_u32 s96, 10
    s_cselect_b32 s95, s34, s35
    s_add_u32 s12, s95, s96
    s_add_u32 s96, s96, 1
    s_cmp_eq_u32 s96, 22
    s_cselect_b32 s96, 0, s96
    ds_read_b64_tr_b16 v[108:109], v21 offset:5120
    ds_read_b64_tr_b16 v[110:111], v21 offset:5632
    s_waitcnt lgkmcnt(9)
    v_mfma_f32_32x32x16_bf16 v[160:175], v[124:127], a[156:159], v[160:175]
    s_cmp_lt_u32 s96, 10
    s_cselect_b32 s95, s34, s35
    s_add_u32 s13, s95, s96
    s_add_u32 s96, s96, 1
    s_cmp_eq_u32 s96, 22
    s_cselect_b32 s96, 0, s96
    ds_read_b64_tr_b16 v[112:113], v21 offset:8192
    ds_read_b64_tr_b16 v[114:115], v21 offset:8704
    s_waitcnt lgkmcnt(8)
    v_mfma_f32_32x32x16_bf16 v[176:191], v[96:99], a[0:3], 0
    s_mul_i32 s90, s71, 120
    s_mul_i32 s91, s66, 30
    s_add_u32 s90, s90, s91
    s_add_u32 s92, s28, 1081472
    s_cmp_ge_u32 s92, 1966080
    s_cselect_b32 s93, 1966080, 0
    s_add_u32 m0, s99, 65536
    s_sub_u32 s92, s92, s93
    buffer_load_dwordx4 v4, s[52:55], s92 offen lds
    s_cmp_lt_u32 s96, 10
    s_cselect_b32 s95, s34, s35
    s_add_u32 s14, s95, s96
    s_add_u32 s96, s96, 1
    s_cmp_eq_u32 s96, 22
    s_cselect_b32 s96, 0, s96
    ds_read_b64_tr_b16 v[116:117], v21 offset:9216
    ds_read_b64_tr_b16 v[118:119], v21 offset:9728
    s_waitcnt lgkmcnt(8)
    v_mfma_f32_32x32x16_bf16 v[176:191], v[100:103], a[4:7], v[176:191]
    v_and_b32 v83, 31, v0
    v_min_u32 v82, 29, v83
    v_add_u32 v82, s90, v82
    s_cmp_lt_u32 s96, 10
    s_cselect_b32 s95, s34, s35
    s_add_u32 s15, s95, s96
    s_add_u32 s96, s96, 1
    s_cmp_eq_u32 s96, 22
    s_cselect_b32 s96, 0, s96
    ds_read_b64_tr_b16 v[120:121], v21 offset:12288
    ds_read_b64_tr_b16 v[122:123], v21 offset:12800
    s_waitcnt lgkmcnt(8)
    v_mfma_f32_32x32x16_bf16 v[176:191], v[104:107], a[8:11], v[176:191]
    s_lshr_b32 s90, s66, 1
    s_mul_i32 s90, s90, 400
    s_mul_i32 s91, s71, 50
    s_add_u32 s92, s28, 1179776
    s_cmp_ge_u32 s92, 1966080
    s_cselect_b32 s93, 1966080, 0
    s_add_u32 m0, s99, 69632
    s_sub_u32 s92, s92, s93
    buffer_load_dwordx4 v4, s[52:55], s92 offen lds
    ds_read_b64_tr_b16 v[124:125], v21 offset:13312
    ds_read_b64_tr_b16 v[126:127], v21 offset:13824
    s_waitcnt lgkmcnt(8)
    v_mfma_f32_32x32x16_bf16 v[176:191], v[108:111], a[12:15], v[176:191]
    s_add_u32 s90, s90, s91
    s_and_b32 s91, s66, 1
    s_mul_i32 s91, s91, 25
    s_cmp_lt_u32 s96, 10
    s_cselect_b32 s95, s34, s35
    s_add_u32 s16, s95, s96
    s_add_u32 s96, s96, 1
    s_cmp_eq_u32 s96, 22
    s_cselect_b32 s96, 0, s96
    ds_read_b64_tr_b16 v[96:97], v21 offset:16384
    ds_read_b64_tr_b16 v[98:99], v21 offset:16896
    s_waitcnt lgkmcnt(8)
    v_mfma_f32_32x32x16_bf16 v[176:191], v[112:115], a[16:19], v[176:191]
    s_add_u32 s90, s90, s91
    v_min_u32 v83, 24, v83
    v_add_u32 v83, s90, v83
    s_add_u32 s92, s28, 1278080
    s_cmp_ge_u32 s92, 1966080
    s_cselect_b32 s93, 1966080, 0
    s_add_u32 m0, s99, 73728
    s_sub_u32 s92, s92, s93
    buffer_load_dwordx4 v4, s[52:55], s92 offen lds
    ds_read_b64_tr_b16 v[100:101], v21 offset:17408
    ds_read_b64_tr_b16 v[102:103], v21 offset:17920
    s_waitcnt lgkmcnt(8)
    v_mfma_f32_32x32x16_bf16 v[176:191], v[116:119], a[20:23], v[176:191]
    v_cmp_gt_u32 vcc, 32, v0
    s_nop 1
    v_cndmask_b32 v82, v83, v82, vcc
    v_lshlrev_b32 v82, 3, v82
    v_add_u32 v82, 0x4000, v82
    ds_read_b64_tr_b16 v[104:105], v21 offset:20480
    ds_read_b64_tr_b16 v[106:107], v21 offset:20992
    s_waitcnt lgkmcnt(8)
    v_mfma_f32_32x32x16_bf16 v[176:191], v[120:123], a[24:27], v[176:191]
    buffer_load_dwordx2 v[80:81], v82, s[40:43], 0 offen sc1
    s_add_u32 s92, s28, 1376384
    s_cmp_ge_u32 s92, 1966080
    s_cselect_b32 s93, 1966080, 0
    s_add_u32 m0, s99, 77824
    s_sub_u32 s92, s92, s93
    buffer_load_dwordx4 v4, s[52:55], s92 offen lds
    s_cmp_lt_u32 s96, 10
    s_cselect_b32 s95, s34, s35
    s_add_u32 s17, s95, s96
    s_add_u32 s96, s96, 1
    s_cmp_eq_u32 s96, 22
    s_cselect_b32 s96, 0, s96
    ds_read_b64_tr_b16 v[108:109], v21 offset:21504
    ds_read_b64_tr_b16 v[110:111], v21 offset:22016
    s_waitcnt lgkmcnt(8)
    v_mfma_f32_32x32x16_bf16 v[176:191], v[124:127], a[28:31], v[176:191]
    s_cmp_lt_u32 s96, 10
    s_cselect_b32 s95, s34, s35
    s_add_u32 s18, s95, s96
    s_add_u32 s96, s96, 1
    s_cmp_eq_u32 s96, 22
    s_cselect_b32 s96, 0, s96
    ds_read_b64_tr_b16 v[112:113], v21 offset:24576
    ds_read_b64_tr_b16 v[114:115], v21 offset:25088
    s_waitcnt lgkmcnt(8)
    v_mfma_f32_32x32x16_bf16 v[176:191], v[96:99], a[32:35], v[176:191]
    s_cmp_lt_u32 s96, 10
    s_cselect_b32 s95, s34, s35
    s_add_u32 s19, s95, s96
    s_add_u32 s96, s96, 1
    s_cmp_eq_u32 s96, 22
    s_cselect_b32 s96, 0, s96
    ds_read_b64_tr_b16 v[116:117], v21 offset:25600
    ds_read_b64_tr_b16 v[118:119], v21 offset:26112
    s_waitcnt lgkmcnt(8)
    v_mfma_f32_32x32x16_bf16 v[176:191], v[100:103], a[36:39], v[176:191]
    s_mov_b32 s29, s96
    ds_read_b64_tr_b16 v[120:121], v21 offset:28672
    ds_read_b64_tr_b16 v[122:123], v21 offset:29184
    s_barrier
    s_waitcnt lgkmcnt(8)
    v_mfma_f32_32x32x16_bf16 v[176:191], v[104:107], a[40:43], v[176:191]
    s_add_u32 s92, s28, 1474688
    s_cmp_ge_u32 s92, 1966080
    s_cselect_b32 s93, 1966080, 0
    s_add_u32 m0, s99, 0
    s_sub_u32 s92, s92, s93
    buffer_load_dwordx4 v4, s[52:55], s92 offen lds
    v_mul_f32 v160, v13, v160
    ds_read_b64_tr_b16 v[124:125], v21 offset:29696
    ds_read_b64_tr_b16 v[126:127], v21 offset:30208
    s_waitcnt lgkmcnt(8)
    v_mfma_f32_32x32x16_bf16 v[176:191], v[108:111], a[44:47], v[176:191]
    v_mul_f32 v161, v13, v161
    v_mul_f32 v162, v13, v162
    v_mul_f32 v163, v13, v163
    ds_read_b64_tr_b16 v[96:97], v21 offset:32768
    ds_read_b64_tr_b16 v[98:99], v21 offset:33280
    s_waitcnt lgkmcnt(8)
    v_mfma_f32_32x32x16_bf16 v[176:191], v[112:115], a[48:51], v[176:191]
    s_add_u32 s92, s28, 1572992
    s_cmp_ge_u32 s92, 1966080
    s_cselect_b32 s93, 1966080, 0
    s_add_u32 m0, s99, 4096
    s_sub_u32 s92, s92, s93
    buffer_load_dwordx4 v4, s[52:55], s92 offen lds
    v_mul_f32 v164, v13, v164
    ds_read_b64_tr_b16 v[100:101], v21 offset:33792
    ds_read_b64_tr_b16 v[102:103], v21 offset:34304
    s_waitcnt lgkmcnt(8)
    v_mfma_f32_32x32x16_bf16 v[176:191], v[116:119], a[52:55], v[176:191]
    v_mul_f32 v165, v13, v165
    v_mul_f32 v166, v13, v166
    v_mul_f32 v167, v13, v167
    ds_read_b64_tr_b16 v[104:105], v21 offset:36864
    ds_read_b64_tr_b16 v[106:107], v21 offset:37376
    s_waitcnt lgkmcnt(8)
    v_mfma_f32_32x32x16_bf16 v[176:191], v[120:123], a[56:59], v[176:191]
    s_add_u32 s92, s28, 1671296
    s_cmp_ge_u32 s92, 1966080
    s_cselect_b32 s93, 1966080, 0
    s_add_u32 m0, s99, 8192
    s_sub_u32 s92, s92, s93
    buffer_load_dwordx4 v4, s[52:55], s92 offen lds
    v_mul_f32 v168, v13, v168
    ds_read_b64_tr_b16 v[108:109], v21 offset:37888
    ds_read_b64_tr_b16 v[110:111], v21 offset:38400
    s_waitcnt lgkmcnt(8)
    v_mfma_f32_32x32x16_bf16 v[176:191], v[124:127], a[60:63], v[176:191]
    v_mul_f32 v169, v13, v169
    v_mul_f32 v170, v13, v170
    v_mul_f32 v171, v13, v171
    ds_read_b64_tr_b16 v[112:113], v23 offset:20480
    ds_read_b64_tr_b16 v[114:115], v23 offset:20992
    s_waitcnt lgkmcnt(8)
    v_mfma_f32_32x32x16_bf16 v[176:191], v[96:99], a[64:67], v[176:191]
    s_add_u32 s92, s28, 1769600
    s_cmp_ge_u32 s92, 1966080
    s_cselect_b32 s93, 1966080, 0
    s_add_u32 m0, s99, 12288
    s_sub_u32 s92, s92, s93
    buffer_load_dwordx4 v4, s[52:55], s92 offen lds
    ds_read_b64_tr_b16 v[116:117], v23 offset:21504
    ds_read_b64_tr_b16 v[118:119], v23 offset:22016
    s_waitcnt lgkmcnt(8)
    v_mfma_f32_32x32x16_bf16 v[176:191], v[100:103], a[68:71], v[176:191]
    v_mul_f32 v172, v13, v172
    v_mul_f32 v173, v13, v173
    v_mul_f32 v174, v13, v174
    ds_read_b64_tr_b16 v[120:121], v23 offset:24576
    ds_read_b64_tr_b16 v[122:123], v23 offset:25088
    s_waitcnt lgkmcnt(8)
    v_mfma_f32_32x32x16_bf16 v[176:191], v[104:107], a[72:75], v[176:191]
    s_add_u32 s92, s28, 1867904
    s_cmp_ge_u32 s92, 1966080
    s_cselect_b32 s93, 1966080, 0
    s_add_u32 m0, s99, 16384
    s_sub_u32 s92, s92, s93
    buffer_load_dwordx4 v4, s[52:55], s92 offen lds
    v_mul_f32 v175, v13, v175
    ds_read_b64_tr_b16 v[124:125], v23 offset:25600
    ds_read_b64_tr_b16 v[126:127], v23 offset:26112
    s_waitcnt lgkmcnt(8)
    v_mfma_f32_32x32x16_bf16 v[176:191], v[108:111], a[76:79], v[176:191]
    v_cvt_pk_bf16_f32 v160, v160, v161
    v_cvt_pk_bf16_f32 v161, v162, v163
    v_cvt_pk_bf16_f32 v162, v164, v165
    ds_read_b64_tr_b16 v[96:97], v23 offset:28672
    ds_read_b64_tr_b16 v[98:99], v23 offset:29184
    s_waitcnt lgkmcnt(8)
    v_mfma_f32_32x32x16_bf16 v[176:191], v[112:115], a[80:83], v[176:191]
    v_cvt_pk_bf16_f32 v163, v166, v167
    v_cvt_pk_bf16_f32 v164, v168, v169
    v_cvt_pk_bf16_f32 v165, v170, v171
    ds_read_b64_tr_b16 v[100:101], v23 offset:29696
    ds_read_b64_tr_b16 v[102:103], v23 offset:30208
    s_waitcnt lgkmcnt(8)
    v_mfma_f32_32x32x16_bf16 v[176:191], v[116:119], a[84:87], v[176:191]
    v_cvt_pk_bf16_f32 v166, v172, v173
    v_cvt_pk_bf16_f32 v167, v174, v175
    v_pk_max_i16 v160, v160, 0
    ds_read_b64_tr_b16 v[104:105], v23 offset:32768
    ds_read_b64_tr_b16 v[106:107], v23 offset:33280
    s_waitcnt vmcnt(6)
    v_xor_b32 v80, s64, v80
    v_xor_b32 v81, s65, v81
    v_or_b32 v80, v80, v81
    v_cmp_ne_u32 vcc, 0, v80
    s_nop 3
    s_cmp_eq_u64 vcc, 0
    s_cbranch_scc1 L_wfA_ok
    s_mov_b32 s91, 0
    s_waitcnt vmcnt(0) lgkmcnt(0)
L_wfA:
    buffer_load_dwordx2 v[80:81], v82, s[40:43], 0 offen sc1
    s_add_u32 s91, s91, 1
    s_waitcnt vmcnt(0)
    v_xor_b32 v80, s64, v80
    v_xor_b32 v81, s65, v81
    v_or_b32 v80, v80, v81
    v_cmp_ne_u32 vcc, 0, v80
    s_nop 3
    s_cmp_eq_u64 vcc, 0
    s_cbranch_scc1 L_wfA_ok
    s_cmp_lt_u32 s91, 0x30d40
    s_cbranch_scc1 L_wfA
L_wfA_ok:
    s_waitcnt lgkmcnt(8)
    v_mfma_f32_32x32x16_bf16 v[176:191], v[120:123], a[88:91], v[176:191]
    v_pk_max_i16 v161, v161, 0
    v_pk_max_i16 v162, v162, 0
    v_pk_max_i16 v163, v163, 0
    ds_read_b64_tr_b16 v[108:109], v23 offset:33792
    ds_read_b64_tr_b16 v[110:111], v23 offset:34304
    s_waitcnt lgkmcnt(8)
    v_mfma_f32_32x32x16_bf16 v[176:191], v[124:127], a[92:95], v[176:191]
    v_pk_max_i16 v164, v164, 0
    v_pk_max_i16 v165, v165, 0
    v_pk_max_i16 v166, v166, 0
    ds_read_b64_tr_b16 v[112:113], v23 offset:36864
    ds_read_b64_tr_b16 v[114:115], v23 offset:37376
    s_waitcnt lgkmcnt(8)
    v_mfma_f32_32x32x16_bf16 v[176:191], v[96:99], a[96:99], v[176:191]
    v_pk_max_i16 v167, v167, 0
    s_add_u32 s94, s22, 0
    buffer_store_dwordx4 v[160:163], v5, s[40:43], s94 offen sc1
    s_mul_i32 s26, s4, 5120
    s_add_u32 s26, s26, s24
    buffer_load_dwordx4 a[160:163], v14, s[40:43], s26 offen offset:0 sc1
    ds_read_b64_tr_b16 v[116:117], v23 offset:37888
    ds_read_b64_tr_b16 v[118:119], v23 offset:38400
    s_waitcnt lgkmcnt(8)
    v_mfma_f32_32x32x16_bf16 v[176:191], v[100:103], a[100:103], v[176:191]
    buffer_store_dwordx4 v[164:167], v5, s[40:43], s94 offen offset:512 sc1
    v_mul_f32 v84, v38, v144
    v_mul_f32 v144, v37, v144
    ds_read_b64_tr_b16 v[120:121], v23 offset:40960
    ds_read_b64_tr_b16 v[122:123], v23 offset:41472
    s_waitcnt lgkmcnt(8)
    v_mfma_f32_32x32x16_bf16 v[176:191], v[104:107], a[104:107], v[176:191]
    buffer_load_dwordx4 a[164:167], v14, s[40:43], s26 offen offset:1024 sc1
    v_fmac_f32 v144, v38, v128
    v_fma_f32 v128, v37, v128, -v84
    ds_read_b64_tr_b16 v[124:125], v23 offset:41984
    ds_read_b64_tr_b16 v[126:127], v23 offset:42496
    s_waitcnt lgkmcnt(8)
    v_mfma_f32_32x32x16_bf16 v[176:191], v[108:111], a[108:111], v[176:191]
    v_mul_f32 v85, v38, v145
    v_mul_f32 v145, v37, v145
    v_fmac_f32 v145, v38, v129
    ds_read_b64_tr_b16 v[96:97], v23 offset:45056
    ds_read_b64_tr_b16 v[98:99], v23 offset:45568
    s_waitcnt lgkmcnt(8)
    v_mfma_f32_32x32x16_bf16 v[176:191], v[112:115], a[112:115], v[176:191]
    buffer_load_dwordx4 a[168:171], v14, s[40:43], s26 offen offset:2048 sc1
    v_fma_f32 v129, v37, v129, -v85
    v_mul_f32 v84, v38, v146
    ds_read_b64_tr_b16 v[100:101], v23 offset:46080
    ds_read_b64_tr_b16 v[102:103], v23 offset:46592
    s_waitcnt lgkmcnt(8)
    v_mfma_f32_32x32x16_bf16 v[176:191], v[116:119], a[116:119], v[176:191]
    v_mul_f32 v146, v37, v146
    v_fmac_f32 v146, v38, v130
    v_fma_f32 v130, v37, v130, -v84
    ds_read_b64_tr_b16 v[104:105], v23 offset:49152
    ds_read_b64_tr_b16 v[106:107], v23 offset:49664
    s_waitcnt lgkmcnt(8)
    v_mfma_f32_32x32x16_bf16 v[176:191], v[120:123], a[120:123], v[176:191]
    buffer_load_dwordx4 a[172:175], v14, s[40:43], s26 offen offset:3072 sc1
    v_mul_f32 v85, v38, v147
    v_mul_f32 v147, v37, v147
    ds_read_b64_tr_b16 v[108:109], v23 offset:50176
    ds_read_b64_tr_b16 v[110:111], v23 offset:50688
    s_waitcnt lgkmcnt(8)
    v_mfma_f32_32x32x16_bf16 v[176:191], v[124:127], a[124:127], v[176:191]
    v_fmac_f32 v147, v38, v131
    v_fma_f32 v131, v37, v131, -v85
    v_mul_f32 v84, v38, v148
    ds_read_b64_tr_b16 v[112:113], v23 offset:53248
    ds_read_b64_tr_b16 v[114:115], v23 offset:53760
    s_waitcnt lgkmcnt(8)
    v_mfma_f32_32x32x16_bf16 v[176:191], v[96:99], a[128:131], v[176:191]
    buffer_load_dwordx4 a[176:179], v15, s[40:43], s26 offen sc1
    v_mul_f32 v148, v37, v148
    v_fmac_f32 v148, v38, v132
    ds_read_b64_tr_b16 v[116:117], v23 offset:54272
    ds_read_b64_tr_b16 v[118:119], v23 offset:54784
    s_waitcnt lgkmcnt(8)
    v_mfma_f32_32x32x16_bf16 v[176:191], v[100:103], a[132:135], v[176:191]
    v_fma_f32 v132, v37, v132, -v84
    v_mul_f32 v85, v38, v149
    v_mul_f32 v149, v37, v149
    ds_read_b64_tr_b16 v[120:121], v23 offset:57344
    ds_read_b64_tr_b16 v[122:123], v23 offset:57856
    s_waitcnt lgkmcnt(8)
    v_mfma_f32_32x32x16_bf16 v[176:191], v[104:107], a[136:139], v[176:191]
    s_mul_i32 s26, s5, 5120
    s_add_u32 s26, s26, s24
    buffer_load_dwordx4 a[180:183], v14, s[40:43], s26 offen offset:0 sc1
    v_fmac_f32 v149, v38, v133
    ds_read_b64_tr_b16 v[124:125], v23 offset:58368
    ds_read_b64_tr_b16 v[126:127], v23 offset:58880
    s_waitcnt lgkmcnt(8)
    v_mfma_f32_32x32x16_bf16 v[176:191], v[108:111], a[140:143], v[176:191]
    v_fma_f32 v133, v37, v133, -v85
    v_mul_f32 v84, v38, v150
    v_mul_f32 v150, v37, v150
    s_waitcnt vmcnt(13)
    s_waitcnt vmcnt(8)
    s_barrier
    ds_read_b64_tr_b16 v[96:97], v24 offset:0
    ds_read_b64_tr_b16 v[98:99], v24 offset:512
    s_waitcnt lgkmcnt(8)
    v_mfma_f32_32x32x16_bf16 v[176:191], v[112:115], a[144:147], v[176:191]
    buffer_load_dwordx4 a[184:187], v14, s[40:43], s26 offen offset:1024 sc1
    v_fmac_f32 v150, v38, v134
    v_fma_f32 v134, v37, v134, -v84
    v_mul_f32 v85, v38, v151
    ds_read_b64_tr_b16 v[100:101], v24 offset:1024
    ds_read_b64_tr_b16 v[102:103], v24 offset:1536
    s_waitcnt lgkmcnt(8)
    v_mfma_f32_32x32x16_bf16 v[176:191], v[116:119], a[148:151], v[176:191]
    s_add_u32 s95, s68, 0
    s_lshl_b32 s95, s95, 13
    s_add_u32 s95, s95, 0x10000
    buffer_load_dwordx4 v[56:59], v7, s[40:43], s95 offen sc1
    buffer_load_dwordx4 v[60:63], v8, s[40:43], s95 offen sc1
    v_mul_f32 v151, v37, v151
    v_fmac_f32 v151, v38, v135
    ds_read_b64_tr_b16 v[104:105], v24 offset:4096
    ds_read_b64_tr_b16 v[106:107], v24 offset:4608
    s_waitcnt lgkmcnt(8)
    v_mfma_f32_32x32x16_bf16 v[176:191], v[120:123], a[152:155], v[176:191]
    buffer_load_dwordx4 a[188:191], v14, s[40:43], s26 offen offset:2048 sc1
    v_fma_f32 v135, v37, v135, -v85
    v_mul_f32 v84, v38, v152
    v_mul_f32 v152, v37, v152
    ds_read_b64_tr_b16 v[108:109], v24 offset:5120
    ds_read_b64_tr_b16 v[110:111], v24 offset:5632
    s_waitcnt lgkmcnt(8)
    v_mfma_f32_32x32x16_bf16 v[176:191], v[124:127], a[156:159], v[176:191]
    v_fmac_f32 v152, v38, v136
    v_fma_f32 v136, v37, v136, -v84
    v_mul_f32 v85, v38, v153
    v_and_b32 v86, 31, v0
    ds_read_b64_tr_b16 v[112:113], v24 offset:8192
    ds_read_b64_tr_b16 v[114:115], v24 offset:8704
    s_waitcnt lgkmcnt(8)
    v_mfma_f32_32x32x16_bf16 v[160:175], v[96:99], a[0:3], 0
    buffer_load_dwordx4 a[192:195], v14, s[40:43], s26 offen offset:3072 sc1
    v_mul_f32 v153, v37, v153
    v_fmac_f32 v153, v38, v137
    v_fma_f32 v137, v37, v137, -v85
    ds_read_b64_tr_b16 v[116:117], v24 offset:9216
    ds_read_b64_tr_b16 v[118:119], v24 offset:9728
    s_waitcnt lgkmcnt(8)
    v_mfma_f32_32x32x16_bf16 v[160:175], v[100:103], a[4:7], v[160:175]
    v_mul_f32 v84, v38, v154
    v_mul_f32 v154, v37, v154
    v_fmac_f32 v154, v38, v138
    v_lshrrev_b32 v88, 3, v86
    ds_read_b64_tr_b16 v[120:121], v24 offset:12288
    ds_read_b64_tr_b16 v[122:123], v24 offset:12800
    s_waitcnt lgkmcnt(8)
    v_mfma_f32_32x32x16_bf16 v[160:175], v[104:107], a[8:11], v[160:175]
    buffer_load_dwordx4 a[196:199], v15, s[40:43], s26 offen sc1
    v_fma_f32 v138, v37, v138, -v84
    v_mul_f32 v85, v38, v155
    v_mul_f32 v155, v37, v155
    ds_read_b64_tr_b16 v[124:125], v24 offset:13312
    ds_read_b64_tr_b16 v[126:127], v24 offset:13824
    s_waitcnt lgkmcnt(8)
    v_mfma_f32_32x32x16_bf16 v[160:175], v[108:111], a[12:15], v[160:175]
    v_fmac_f32 v155, v38, v139
    v_fma_f32 v139, v37, v139, -v85
    v_mul_f32 v84, v38, v156
    v_mul_f32 v176, v13, v176
    ds_read_b64_tr_b16 v[96:97], v24 offset:16384
    ds_read_b64_tr_b16 v[98:99], v24 offset:16896
    s_waitcnt lgkmcnt(8)
    v_mfma_f32_32x32x16_bf16 v[160:175], v[112:115], a[16:19], v[160:175]
    s_mul_i32 s26, s6, 5120
    s_add_u32 s26, s26, s24
    buffer_load_dwordx4 a[200:203], v14, s[40:43], s26 offen offset:0 sc1
    v_mul_f32 v156, v37, v156
    v_fmac_f32 v156, v38, v140
    ds_read_b64_tr_b16 v[100:101], v24 offset:17408
    ds_read_b64_tr_b16 v[102:103], v24 offset:17920
    s_waitcnt lgkmcnt(8)
    v_mfma_f32_32x32x16_bf16 v[160:175], v[116:119], a[20:23], v[160:175]
    v_fma_f32 v140, v37, v140, -v84
    v_mul_f32 v85, v38, v157
    v_mul_f32 v157, v37, v157
    v_mul_f32 v177, v13, v177
    ds_read_b64_tr_b16 v[104:105], v20 offset:40960
    ds_read_b64_tr_b16 v[106:107], v20 offset:41472
    s_waitcnt lgkmcnt(8)
    v_mfma_f32_32x32x16_bf16 v[160:175], v[120:123], a[24:27], v[160:175]
    buffer_load_dwordx4 a[204:207], v14, s[40:43], s26 offen offset:1024 sc1
    v_fmac_f32 v157, v38, v141
    v_fma_f32 v141, v37, v141, -v85
    v_mul_f32 v84, v38, v158
    ds_read_b64_tr_b16 v[108:109], v20 offset:41984
    ds_read_b64_tr_b16 v[110:111], v20 offset:42496
    s_waitcnt lgkmcnt(8)
    v_mfma_f32_32x32x16_bf16 v[160:175], v[124:127], a[28:31], v[160:175]
    v_mul_f32 v158, v37, v158
    v_fmac_f32 v158, v38, v142
    v_fma_f32 v142, v37, v142, -v84
    v_mul_f32 v178, v13, v178
    ds_read_b64_tr_b16 v[112:113], v20 offset:45056
    ds_read_b64_tr_b16 v[114:115], v20 offset:45568
    s_waitcnt lgkmcnt(8)
    v_mfma_f32_32x32x16_bf16 v[160:175], v[96:99], a[32:35], v[160:175]
    buffer_load_dwordx4 a[208:211], v14, s[40:43], s26 offen offset:2048 sc1
    v_mul_f32 v85, v38, v159
    v_mul_f32 v159, v37, v159
    v_fmac_f32 v159, v38, v143
    ds_read_b64_tr_b16 v[116:117], v20 offset:46080
    ds_read_b64_tr_b16 v[118:119], v20 offset:46592
    s_waitcnt lgkmcnt(8)
    v_mfma_f32_32x32x16_bf16 v[160:175], v[100:103], a[36:39], v[160:175]
    v_fma_f32 v143, v37, v143, -v85
    v_mul_f32 v179, v13, v179
    v_mul_f32 v180, v13, v180
    v_mul_f32 v181, v13, v181
    ds_read_b64_tr_b16 v[120:121], v20 offset:49152
    ds_read_b64_tr_b16 v[122:123], v20 offset:49664
    s_waitcnt lgkmcnt(8)
    v_mfma_f32_32x32x16_bf16 v[160:175], v[104:107], a[40:43], v[160:175]
    buffer_load_dwordx4 a[212:215], v14, s[40:43], s26 offen offset:3072 sc1
    v_mul_f32 v182, v13, v182
    v_mul_f32 v183, v13, v183
    v_mul_f32 v184, v13, v184
    ds_read_b64_tr_b16 v[124:125], v20 offset:50176
    ds_read_b64_tr_b16 v[126:127], v20 offset:50688
    s_waitcnt lgkmcnt(8)
    v_mfma_f32_32x32x16_bf16 v[160:175], v[108:111], a[44:47], v[160:175]
    v_mul_f32 v185, v13, v185
    v_mul_f32 v186, v13, v186
    v_mul_f32 v187, v13, v187
    v_and_b32 v87, 3, v86
    ds_read_b64_tr_b16 v[96:97], v20 offset:53248
    ds_read_b64_tr_b16 v[98:99], v20 offset:53760
    s_waitcnt lgkmcnt(8)
    v_mfma_f32_32x32x16_bf16 v[160:175], v[112:115], a[48:51], v[160:175]
    buffer_load_dwordx4 a[216:219], v15, s[40:43], s26 offen sc1
    v_mul_f32 v188, v13, v188
    v_mul_f32 v189, v13, v189
    v_mul_f32 v190, v13, v190
    ds_read_b64_tr_b16 v[100:101], v20 offset:54272
    ds_read_b64_tr_b16 v[102:103], v20 offset:54784
    s_waitcnt lgkmcnt(8)
    v_mfma_f32_32x32x16_bf16 v[160:175], v[116:119], a[52:55], v[160:175]
    v_mul_f32 v191, v13, v191
    v_cvt_pk_bf16_f32 v176, v176, v177
    v_cvt_pk_bf16_f32 v177, v178, v179
    v_lshl_add_u32 v87, v88, 2, v87
    ds_read_b64_tr_b16 v[104:105], v20 offset:57344
    ds_read_b64_tr_b16 v[106:107], v20 offset:57856
    s_waitcnt lgkmcnt(8)
    v_mfma_f32_32x32x16_bf16 v[160:175], v[120:123], a[56:59], v[160:175]
    s_mul_i32 s26, s7, 5120
    s_add_u32 s26, s26, s24
    buffer_load_dwordx4 a[220:223], v14, s[40:43], s26 offen offset:0 sc1
    v_cvt_pk_bf16_f32 v178, v180, v181
    v_cvt_pk_bf16_f32 v179, v182, v183
    v_cvt_pk_bf16_f32 v180, v184, v185
    ds_read_b64_tr_b16 v[108:109], v20 offset:58368
    ds_read_b64_tr_b16 v[110:111], v20 offset:58880
    s_waitcnt lgkmcnt(8)
    v_mfma_f32_32x32x16_bf16 v[160:175], v[124:127], a[60:63], v[160:175]
    v_cvt_pk_bf16_f32 v181, v186, v187
    v_cvt_pk_bf16_f32 v182, v188, v189
    v_cvt_pk_bf16_f32 v183, v190, v191
    v_bfe_u32 v88, v86, 2, 1
    ds_read_b64_tr_b16 v[112:113], v22 offset:0
    ds_read_b64_tr_b16 v[114:115], v22 offset:512
    s_waitcnt lgkmcnt(8)
    v_mfma_f32_32x32x16_bf16 v[160:175], v[96:99], a[64:67], v[160:175]
    buffer_load_dwordx4 a[224:227], v14, s[40:43], s26 offen offset:1024 sc1
    v_pk_max_i16 v176, v176, 0
    v_pk_max_i16 v177, v177, 0
    v_pk_max_i16 v178, v178, 0
    ds_read_b64_tr_b16 v[116:117], v22 offset:1024
    ds_read_b64_tr_b16 v[118:119], v22 offset:1536
    s_waitcnt lgkmcnt(8)
    v_mfma_f32_32x32x16_bf16 v[160:175], v[100:103], a[68:71], v[160:175]
    v_pk_max_i16 v179, v179, 0
    v_pk_max_i16 v180, v180, 0
    v_pk_max_i16 v181, v181, 0
    v_lshrrev_b32 v89, 5, v0
    ds_read_b64_tr_b16 v[120:121], v22 offset:4096
    ds_read_b64_tr_b16 v[122:123], v22 offset:4608
    s_waitcnt lgkmcnt(8)
    v_mfma_f32_32x32x16_bf16 v[160:175], v[104:107], a[72:75], v[160:175]
    buffer_load_dwordx4 a[228:231], v14, s[40:43], s26 offen offset:2048 sc1
    v_pk_max_i16 v182, v182, 0
    v_pk_max_i16 v183, v183, 0
    s_add_u32 s94, s22, 4096
    ds_read_b64_tr_b16 v[124:125], v22 offset:5120
    ds_read_b64_tr_b16 v[126:127], v22 offset:5632
    s_waitcnt lgkmcnt(8)
    v_mfma_f32_32x32x16_bf16 v[160:175], v[108:111], a[76:79], v[160:175]
    buffer_store_dwordx4 v[176:179], v5, s[40:43], s94 offen sc1
    buffer_store_dwordx4 v[180:183], v5, s[40:43], s94 offen offset:512 sc1
    v_cmp_eq_u32 vcc, v88, v89
    s_nop 1
    v_cndmask_b32 v87, 31, v87, vcc
    ds_read_b64_tr_b16 v[96:97], v22 offset:8192
    ds_read_b64_tr_b16 v[98:99], v22 offset:8704
    s_waitcnt vmcnt(14)
    v_xor_b32 v64, s64, v57
    v_xor_b32 v65, s64, v59
    s_waitcnt vmcnt(13)
    v_xor_b32 v66, s64, v61
    v_xor_b32 v67, s64, v63
    v_or3_b32 v64, v64, v65, v66
    v_or_b32 v64, v64, v67
    v_cmp_ne_u32 vcc, 0, v64
    s_nop 3
    s_cmp_eq_u64 vcc, 0
    s_cbranch_scc1 L_lbA_ok
    s_mov_b32 s91, 0
    s_waitcnt vmcnt(0) lgkmcnt(0)
L_lbA:
    buffer_load_dwordx4 v[56:59], v7, s[40:43], s95 offen sc1
    buffer_load_dwordx4 v[60:63], v8, s[40:43], s95 offen sc1
    s_add_u32 s91, s91, 1
    s_waitcnt vmcnt(1)
    v_xor_b32 v64, s64, v57
    v_xor_b32 v65, s64, v59
    s_waitcnt vmcnt(0)
    v_xor_b32 v66, s64, v61
    v_xor_b32 v67, s64, v63
    v_or3_b32 v64, v64, v65, v66
    v_or_b32 v64, v64, v67
    v_cmp_ne_u32 vcc, 0, v64
    s_nop 3
    s_cmp_eq_u64 vcc, 0
    s_cbranch_scc1 L_lbA_ok
    s_cmp_lt_u32 s91, 0x30d40
    s_cbranch_scc1 L_lbA
L_lbA_ok:
    v_mul_f32 v64, v33, v56
    v_mul_f32 v65, v33, v58
    v_fma_f32 v64, -v34, v58, v64
    v_fmac_f32 v65, v34, v56
    v_fmac_f32 v64, v35, v60
    v_fmac_f32 v65, v35, v62
    v_fma_f32 v64, -v36, v62, v64
    v_fmac_f32 v65, v36, v60
    ds_write_b64 v9, v[64:65] offset:6656
    s_waitcnt lgkmcnt(0)
    s_barrier
    v_mfma_f32_32x32x16_bf16 v[160:175], v[112:115], a[80:83], v[160:175]
    buffer_load_dwordx4 a[232:235], v14, s[40:43], s26 offen offset:3072 sc1
    v_lshrrev_b32 v89, 16, v12
    v_and_b32 v88, 1, v87
    v_lshlrev_b32 v88, 4, v88
    ds_read_b64_tr_b16 v[100:101], v22 offset:9216
    ds_read_b64_tr_b16 v[102:103], v22 offset:9728
    v_mfma_f32_32x32x16_bf16 v[160:175], v[116:119], a[84:87], v[160:175]
    v_lshlrev_b32 v89, v88, v89
    v_lshrrev_b32 v87, 1, v87
    v_cmp_eq_u32 vcc, 0, v87
    s_nop 1
    v_cndmask_b32 v72, 0, v89, vcc
    ds_read_b64_tr_b16 v[104:105], v22 offset:12288
    ds_read_b64_tr_b16 v[106:107], v22 offset:12800
    v_mfma_f32_32x32x16_bf16 v[160:175], v[120:123], a[88:91], v[160:175]
    buffer_load_dwordx4 a[236:239], v15, s[40:43], s26 offen sc1
    v_cmp_eq_u32 vcc, 1, v87
    s_nop 1
    v_cndmask_b32 v73, 0, v89, vcc
    v_cmp_eq_u32 vcc, 2, v87
    s_nop 1
    v_cndmask_b32 v74, 0, v89, vcc
    ds_read_b64_tr_b16 v[108:109], v22 offset:13312
    ds_read_b64_tr_b16 v[110:111], v22 offset:13824
    v_mfma_f32_32x32x16_bf16 v[160:175], v[124:127], a[92:95], v[160:175]
    v_cmp_eq_u32 vcc, 3, v87
    s_nop 1
    v_cndmask_b32 v75, 0, v89, vcc
    v_cmp_eq_u32 vcc, 4, v87
    s_nop 1
    v_cndmask_b32 v76, 0, v89, vcc
    ds_read_b64_tr_b16 v[112:113], v22 offset:16384
    ds_read_b64_tr_b16 v[114:115], v22 offset:16896
    v_mfma_f32_32x32x16_bf16 v[160:175], v[96:99], a[96:99], v[160:175]
    s_mul_i32 s26, s8, 5120
    s_add_u32 s26, s26, s24
    buffer_load_dwordx4 a[240:243], v14, s[40:43], s26 offen offset:0 sc1
    v_cmp_eq_u32 vcc, 5, v87
    s_nop 1
    v_cndmask_b32 v77, 0, v89, vcc
    ds_read_b64_tr_b16 v[116:117], v22 offset:17408
    ds_read_b64_tr_b16 v[118:119], v22 offset:17920
    s_waitcnt lgkmcnt(8)
    v_mfma_f32_32x32x16_bf16 v[160:175], v[100:103], a[100:103], v[160:175]
    v_cmp_eq_u32 vcc, 6, v87
    s_nop 1
    v_cndmask_b32 v78, 0, v89, vcc
    v_cmp_eq_u32 vcc, 7, v87
    s_nop 1
    v_cndmask_b32 v79, 0, v89, vcc
    ds_read_b64_tr_b16 v[120:121], v20 offset:0
    ds_read_b64_tr_b16 v[122:123], v20 offset:512
    s_waitcnt lgkmcnt(8)
    v_mfma_f32_32x32x16_bf16 v[160:175], v[104:107], a[104:107], v[160:175]
    buffer_load_dwordx4 a[244:247], v14, s[40:43], s26 offen offset:1024 sc1
    ds_read_b128 v[56:59], v10 offset:6656
    ds_read_b128 v[60:63], v10 offset:6672
    ds_read_b128 v[64:67], v10 offset:6688
    ds_read_b64_tr_b16 v[124:125], v20 offset:1024
    ds_read_b64_tr_b16 v[126:127], v20 offset:1536
    s_waitcnt lgkmcnt(11)
    v_mfma_f32_32x32x16_bf16 v[160:175], v[108:111], a[108:111], v[160:175]
    ds_read_b128 v[68:71], v10 offset:6704
    s_waitcnt lgkmcnt(5)
    v_add_f32 v56, v56, v58
    v_add_f32 v57, v57, v59
    s_waitcnt lgkmcnt(4)
    v_add_f32 v60, v60, v62
    ds_read_b64_tr_b16 v[96:97], v20 offset:4096
    ds_read_b64_tr_b16 v[98:99], v20 offset:4608
    v_mfma_f32_32x32x16_bf16 v[160:175], v[112:115], a[112:115], v[160:175]
    buffer_load_dwordx4 a[248:251], v14, s[40:43], s26 offen offset:2048 sc1
    v_add_f32 v61, v61, v63
    s_waitcnt lgkmcnt(5)
    v_add_f32 v64, v64, v66
    v_add_f32 v65, v65, v67
    ds_read_b64_tr_b16 v[100:101], v20 offset:5120
    ds_read_b64_tr_b16 v[102:103], v20 offset:5632
    v_mfma_f32_32x32x16_bf16 v[160:175], v[116:119], a[116:119], v[160:175]
    s_waitcnt lgkmcnt(4)
    v_add_f32 v68, v68, v70
    v_add_f32 v69, v69, v71
    v_add_f32 v56, v56, v60
    v_add_f32 v57, v57, v61
    ds_read_b64_tr_b16 v[104:105], v20 offset:8192
    ds_read_b64_tr_b16 v[106:107], v20 offset:8704
    v_mfma_f32_32x32x16_bf16 v[160:175], v[120:123], a[120:123], v[160:175]
    buffer_load_dwordx4 a[252:255], v14, s[40:43], s26 offen offset:3072 sc1
    v_add_f32 v64, v64, v68
    v_add_f32 v65, v65, v69
    v_add_f32 v56, v56, v64
    ds_read_b64_tr_b16 v[108:109], v20 offset:9216
    ds_read_b64_tr_b16 v[110:111], v20 offset:9728
    v_mfma_f32_32x32x16_bf16 v[160:175], v[124:127], a[124:127], v[160:175]
    v_add_f32 v57, v57, v65
    v_fmac_f32 v48, v31, v56
    v_fmac_f32 v49, v31, v57
    v_fma_f32 v48, -v32, v57, v48
    ds_read_b64_tr_b16 v[112:113], v20 offset:12288
    ds_read_b64_tr_b16 v[114:115], v20 offset:12800
    s_waitcnt lgkmcnt(8)
    v_mfma_f32_32x32x16_bf16 v[160:175], v[96:99], a[128:131], v[160:175]
    buffer_load_dwordx4 v[192:195], v15, s[40:43], s26 offen sc1
    v_fmac_f32 v49, v32, v56
    v_mul_f32 v58, v37, v48
    v_mul_f32 v59, v37, v49
    ds_read_b64_tr_b16 v[116:117], v20 offset:13312
    ds_read_b64_tr_b16 v[118:119], v20 offset:13824
    s_waitcnt lgkmcnt(8)
    v_mfma_f32_32x32x16_bf16 v[160:175], v[100:103], a[132:135], v[160:175]
    v_fma_f32 v58, -v38, v49, v58
    v_fmac_f32 v59, v38, v48
    v_fmac_f32 v128, v26, v58
    v_fmac_f32 v144, v26, v59
    ds_read_b64_tr_b16 v[120:121], v20 offset:16384
    ds_read_b64_tr_b16 v[122:123], v20 offset:16896
    s_waitcnt lgkmcnt(8)
    v_mfma_f32_32x32x16_bf16 v[160:175], v[104:107], a[136:139], v[160:175]
    s_mul_i32 s26, s9, 5120
    s_add_u32 s26, s26, s24
    buffer_load_dwordx4 v[196:199], v14, s[40:43], s26 offen offset:0 sc1
    v_fmac_f32 v128, v28, v59
    v_fmac_f32 v144, v27, v58
    ds_read_b64_tr_b16 v[124:125], v20 offset:17408
    ds_read_b64_tr_b16 v[126:127], v20 offset:17920
    s_waitcnt lgkmcnt(8)
    v_mfma_f32_32x32x16_bf16 v[160:175], v[108:111], a[140:143], v[160:175]
    v_fmac_f32 v129, v26, v128
    v_fmac_f32 v145, v26, v144
    v_fmac_f32 v129, v28, v144
    v_fmac_f32 v145, v27, v128
    ds_read_b64_tr_b16 v[96:97], v25 offset:0
    ds_read_b64_tr_b16 v[98:99], v25 offset:512
    s_waitcnt lgkmcnt(8)
    v_mfma_f32_32x32x16_bf16 v[160:175], v[112:115], a[144:147], v[160:175]
    buffer_load_dwordx4 v[200:203], v14, s[40:43], s26 offen offset:1024 sc1
    v_fmac_f32 v130, v26, v129
    v_fmac_f32 v146, v26, v145
    v_fmac_f32 v130, v28, v145
    ds_read_b64_tr_b16 v[100:101], v25 offset:1024
    ds_read_b64_tr_b16 v[102:103], v25 offset:1536
    s_waitcnt lgkmcnt(8)
    v_mfma_f32_32x32x16_bf16 v[160:175], v[116:119], a[148:151], v[160:175]
    v_fmac_f32 v146, v27, v129
    v_fmac_f32 v131, v26, v130
    v_fmac_f32 v147, v26, v146
    v_fmac_f32 v131, v28, v146
    ds_read_b64_tr_b16 v[104:105], v25 offset:4096
    ds_read_b64_tr_b16 v[106:107], v25 offset:4608
    s_waitcnt lgkmcnt(8)
    v_mfma_f32_32x32x16_bf16 v[160:175], v[120:123], a[152:155], v[160:175]
    buffer_load_dwordx4 v[204:207], v14, s[40:43], s26 offen offset:2048 sc1
    v_fmac_f32 v147, v27, v130
    v_fmac_f32 v132, v26, v131
    v_fmac_f32 v148, v26, v147
    ds_read_b64_tr_b16 v[108:109], v25 offset:5120
    ds_read_b64_tr_b16 v[110:111], v25 offset:5632
    s_waitcnt lgkmcnt(8)
    v_mfma_f32_32x32x16_bf16 v[160:175], v[124:127], a[156:159], v[160:175]
    v_fmac_f32 v132, v28, v147
    v_fmac_f32 v148, v27, v131
    v_fmac_f32 v133, v26, v132
    v_fmac_f32 v149, v26, v148
    ds_read_b64_tr_b16 v[112:113], v25 offset:8192
    ds_read_b64_tr_b16 v[114:115], v25 offset:8704
    s_waitcnt lgkmcnt(8)
    v_mfma_f32_32x32x16_bf16 v[176:191], v[96:99], a[0:3], 0
    v_fmac_f32 v133, v28, v148
    v_fmac_f32 v149, v27, v132
    v_fmac_f32 v134, v26, v133
    v_fmac_f32 v150, v26, v149
    ds_read_b64_tr_b16 v[116:117], v25 offset:9216
    ds_read_b64_tr_b16 v[118:119], v25 offset:9728
    s_waitcnt lgkmcnt(8)
    v_mfma_f32_32x32x16_bf16 v[176:191], v[100:103], a[4:7], v[176:191]
    v_fmac_f32 v134, v28, v149
    v_fmac_f32 v150, v27, v133
    v_fmac_f32 v135, v26, v134
    v_fmac_f32 v151, v26, v150
    ds_read_b64_tr_b16 v[120:121], v25 offset:12288
    ds_read_b64_tr_b16 v[122:123], v25 offset:12800
    s_waitcnt lgkmcnt(8)
    v_mfma_f32_32x32x16_bf16 v[176:191], v[104:107], a[8:11], v[176:191]
    v_fmac_f32 v135, v28, v150
    v_fmac_f32 v151, v27, v134
    v_fmac_f32 v136, v26, v135
    v_fmac_f32 v152, v26, v151
    ds_read_b64_tr_b16 v[124:125], v25 offset:13312
    ds_read_b64_tr_b16 v[126:127], v25 offset:13824
    s_waitcnt lgkmcnt(8)
    v_mfma_f32_32x32x16_bf16 v[176:191], v[108:111], a[12:15], v[176:191]
    v_fmac_f32 v136, v28, v151
    v_fmac_f32 v152, v27, v135
    v_fmac_f32 v137, v26, v136
    v_fmac_f32 v153, v26, v152
    ds_read_b64_tr_b16 v[96:97], v25 offset:16384
    ds_read_b64_tr_b16 v[98:99], v25 offset:16896
    s_waitcnt lgkmcnt(8)
    v_mfma_f32_32x32x16_bf16 v[176:191], v[112:115], a[16:19], v[176:191]
    v_fmac_f32 v137, v28, v152
    v_fmac_f32 v153, v27, v136
    v_fmac_f32 v138, v26, v137
    v_fmac_f32 v154, v26, v153
    ds_read_b64_tr_b16 v[100:101], v25 offset:17408
    ds_read_b64_tr_b16 v[102:103], v25 offset:17920
    s_waitcnt lgkmcnt(8)
    v_mfma_f32_32x32x16_bf16 v[176:191], v[116:119], a[20:23], v[176:191]
    v_fmac_f32 v138, v28, v153
    v_fmac_f32 v154, v27, v137
    v_fmac_f32 v139, v26, v138
    v_fmac_f32 v155, v26, v154
    ds_read_b64_tr_b16 v[104:105], v21 offset:40960
    ds_read_b64_tr_b16 v[106:107], v21 offset:41472
    s_waitcnt lgkmcnt(8)
    v_mfma_f32_32x32x16_bf16 v[176:191], v[120:123], a[24:27], v[176:191]
    v_fmac_f32 v139, v28, v154
    v_fmac_f32 v155, v27, v138
    v_fmac_f32 v140, v26, v139
    v_fmac_f32 v156, v26, v155
    ds_read_b64_tr_b16 v[108:109], v21 offset:41984
    ds_read_b64_tr_b16 v[110:111], v21 offset:42496
    s_waitcnt lgkmcnt(8)
    v_mfma_f32_32x32x16_bf16 v[176:191], v[124:127], a[28:31], v[176:191]
    v_fmac_f32 v140, v28, v155
    v_fmac_f32 v156, v27, v139
    v_fmac_f32 v141, v26, v140
    v_fmac_f32 v157, v26, v156
    ds_read_b64_tr_b16 v[112:113], v21 offset:45056
    ds_read_b64_tr_b16 v[114:115], v21 offset:45568
    s_waitcnt lgkmcnt(8)
    v_mfma_f32_32x32x16_bf16 v[176:191], v[96:99], a[32:35], v[176:191]
    v_fmac_f32 v141, v28, v156
    v_fmac_f32 v157, v27, v140
    v_fmac_f32 v142, v26, v141
    v_fmac_f32 v158, v26, v157
    ds_read_b64_tr_b16 v[116:117], v21 offset:46080
    ds_read_b64_tr_b16 v[118:119], v21 offset:46592
    s_waitcnt lgkmcnt(8)
    v_mfma_f32_32x32x16_bf16 v[176:191], v[100:103], a[36:39], v[176:191]
    v_fmac_f32 v142, v28, v157
    v_fmac_f32 v158, v27, v141
    v_fmac_f32 v143, v26, v142
    v_fmac_f32 v159, v26, v158
    ds_read_b64_tr_b16 v[120:121], v21 offset:49152
    ds_read_b64_tr_b16 v[122:123], v21 offset:49664
    s_waitcnt lgkmcnt(8)
    v_mfma_f32_32x32x16_bf16 v[176:191], v[104:107], a[40:43], v[176:191]
    v_fmac_f32 v143, v28, v158
    v_fmac_f32 v159, v27, v142
    v_cvt_pk_bf16_f32 v128, v128, v129
    v_cvt_pk_bf16_f32 v129, v130, v131
    ds_read_b64_tr_b16 v[124:125], v21 offset:50176
    ds_read_b64_tr_b16 v[126:127], v21 offset:50688
    s_waitcnt lgkmcnt(8)
    v_mfma_f32_32x32x16_bf16 v[176:191], v[108:111], a[44:47], v[176:191]
    v_cvt_pk_bf16_f32 v130, v132, v133
    v_cvt_pk_bf16_f32 v131, v134, v135
    v_cvt_pk_bf16_f32 v132, v136, v137
    v_cvt_pk_bf16_f32 v133, v138, v139
    ds_read_b64_tr_b16 v[96:97], v21 offset:53248
    ds_read_b64_tr_b16 v[98:99], v21 offset:53760
    s_waitcnt lgkmcnt(8)
    v_mfma_f32_32x32x16_bf16 v[176:191], v[112:115], a[48:51], v[176:191]
    v_cvt_pk_bf16_f32 v134, v140, v141
    v_cvt_pk_bf16_f32 v135, v142, v143
    v_cvt_pk_bf16_f32 v136, -v144, -v145
    v_cvt_pk_bf16_f32 v137, -v146, -v147
    ds_read_b64_tr_b16 v[100:101], v21 offset:54272
    ds_read_b64_tr_b16 v[102:103], v21 offset:54784
    s_waitcnt lgkmcnt(8)
    v_mfma_f32_32x32x16_bf16 v[176:191], v[116:119], a[52:55], v[176:191]
    v_cvt_pk_bf16_f32 v138, -v148, -v149
    v_cvt_pk_bf16_f32 v139, -v150, -v151
    v_cvt_pk_bf16_f32 v140, -v152, -v153
    v_cvt_pk_bf16_f32 v141, -v154, -v155
    ds_read_b64_tr_b16 v[104:105], v21 offset:57344
    ds_read_b64_tr_b16 v[106:107], v21 offset:57856
    s_waitcnt lgkmcnt(8)
    v_mfma_f32_32x32x16_bf16 v[176:191], v[120:123], a[56:59], v[176:191]
    v_cvt_pk_bf16_f32 v142, -v156, -v157
    v_cvt_pk_bf16_f32 v143, -v158, -v159
    v_mfma_f32_32x32x16_bf16 v[144:159], v[128:131], v[72:75], 0
    ds_read_b64_tr_b16 v[108:109], v21 offset:58368
    ds_read_b64_tr_b16 v[110:111], v21 offset:58880
    s_waitcnt lgkmcnt(8)
    v_mfma_f32_32x32x16_bf16 v[176:191], v[124:127], a[60:63], v[176:191]
    v_mfma_f32_32x32x16_bf16 v[56:71], v[136:139], v[72:75], 0
    v_mfma_f32_32x32x16_bf16 v[144:159], v[132:135], v[76:79], v[144:159]
    ds_read_b64_tr_b16 v[112:113], v23 offset:0
    ds_read_b64_tr_b16 v[114:115], v23 offset:512
    s_waitcnt lgkmcnt(8)
    v_mfma_f32_32x32x16_bf16 v[176:191], v[96:99], a[64:67], v[176:191]
    v_mfma_f32_32x32x16_bf16 v[56:71], v[140:143], v[76:79], v[56:71]
    buffer_load_dwordx4 v[208:211], v14, s[40:43], s26 offen offset:3072 sc1
    v_mul_f32 v160, v13, v160
    ds_read_b64_tr_b16 v[116:117], v23 offset:1024
    ds_read_b64_tr_b16 v[118:119], v23 offset:1536
    s_waitcnt lgkmcnt(8)
    v_mfma_f32_32x32x16_bf16 v[176:191], v[100:103], a[68:71], v[176:191]
    s_nop 0
    v_cvt_pk_bf16_f32 v144, v144, v145
    v_cvt_pk_bf16_f32 v145, v146, v147
    v_cvt_pk_bf16_f32 v146, v148, v149
    v_cvt_pk_bf16_f32 v147, v150, v151
    ds_read_b64_tr_b16 v[120:121], v23 offset:4096
    ds_read_b64_tr_b16 v[122:123], v23 offset:4608
    s_waitcnt lgkmcnt(8)
    v_mfma_f32_32x32x16_bf16 v[176:191], v[104:107], a[72:75], v[176:191]
    v_cvt_pk_bf16_f32 v148, v152, v153
    v_cvt_pk_bf16_f32 v149, v154, v155
    v_cvt_pk_bf16_f32 v150, v156, v157
    v_cvt_pk_bf16_f32 v151, v158, v159
    ds_read_b64_tr_b16 v[124:125], v23 offset:5120
    ds_read_b64_tr_b16 v[126:127], v23 offset:5632
    s_waitcnt lgkmcnt(8)
    v_mfma_f32_32x32x16_bf16 v[176:191], v[108:111], a[76:79], v[176:191]
    s_add_u32 s97, s23, 196608
    buffer_store_dwordx4 v[144:147], v5, s[40:43], s97 offen sc1
    s_add_u32 s97, s23, 196608
    buffer_store_dwordx4 v[148:151], v5, s[40:43], s97 offen offset:512 sc1
    v_cvt_pk_bf16_f32 v56, v56, v57
    v_cvt_pk_bf16_f32 v57, v58, v59
    ds_read_b64_tr_b16 v[96:97], v23 offset:8192
    ds_read_b64_tr_b16 v[98:99], v23 offset:8704
    s_waitcnt lgkmcnt(8)
    v_mfma_f32_32x32x16_bf16 v[176:191], v[112:115], a[80:83], v[176:191]
    v_cvt_pk_bf16_f32 v58, v60, v61
    v_cvt_pk_bf16_f32 v59, v62, v63
    v_cvt_pk_bf16_f32 v60, v64, v65
    v_cvt_pk_bf16_f32 v61, v66, v67
    ds_read_b64_tr_b16 v[100:101], v23 offset:9216
    ds_read_b64_tr_b16 v[102:103], v23 offset:9728
    s_waitcnt lgkmcnt(8)
    v_mfma_f32_32x32x16_bf16 v[176:191], v[116:119], a[84:87], v[176:191]
    v_cvt_pk_bf16_f32 v62, v68, v69
    v_cvt_pk_bf16_f32 v63, v70, v71
    s_add_u32 s97, s23, 278528
    buffer_store_dwordx4 v[56:59], v5, s[40:43], s97 offen sc1
    s_add_u32 s97, s23, 278528
    buffer_store_dwordx4 v[60:63], v5, s[40:43], s97 offen offset:512 sc1
    ds_read_b64_tr_b16 v[104:105], v23 offset:12288
    ds_read_b64_tr_b16 v[106:107], v23 offset:12800
    s_waitcnt lgkmcnt(8)
    v_mfma_f32_32x32x16_bf16 v[176:191], v[120:123], a[88:91], v[176:191]
    buffer_load_dwordx4 v[212:215], v15, s[40:43], s26 offen sc1
    v_mul_f32 v161, v13, v161
    v_mul_f32 v162, v13, v162
    ds_read_b64_tr_b16 v[108:109], v23 offset:13312
    ds_read_b64_tr_b16 v[110:111], v23 offset:13824
    s_waitcnt lgkmcnt(8)
    v_mfma_f32_32x32x16_bf16 v[176:191], v[124:127], a[92:95], v[176:191]
    v_mul_f32 v163, v13, v163
    v_mul_f32 v164, v13, v164
    v_mul_f32 v165, v13, v165
    ds_read_b64_tr_b16 v[112:113], v23 offset:16384
    ds_read_b64_tr_b16 v[114:115], v23 offset:16896
    s_waitcnt lgkmcnt(8)
    v_mfma_f32_32x32x16_bf16 v[176:191], v[96:99], a[96:99], v[176:191]
    s_mul_i32 s26, s10, 5120
    s_add_u32 s26, s26, s24
    buffer_load_dwordx4 v[216:219], v14, s[40:43], s26 offen offset:0 sc1
    v_mul_f32 v166, v13, v166
    v_mul_f32 v167, v13, v167
    v_mul_f32 v168, v13, v168
    ds_read_b64_tr_b16 v[116:117], v23 offset:17408
    ds_read_b64_tr_b16 v[118:119], v23 offset:17920
    s_waitcnt lgkmcnt(8)
    v_mfma_f32_32x32x16_bf16 v[176:191], v[100:103], a[100:103], v[176:191]
    v_mul_f32 v169, v13, v169
    v_mul_f32 v170, v13, v170
    v_mul_f32 v171, v13, v171
    ds_read_b64_tr_b16 v[120:121], v21 offset:0
    ds_read_b64_tr_b16 v[122:123], v21 offset:512
    s_waitcnt lgkmcnt(8)
    v_mfma_f32_32x32x16_bf16 v[176:191], v[104:107], a[104:107], v[176:191]
    buffer_load_dwordx4 v[220:223], v14, s[40:43], s26 offen offset:1024 sc1
    v_mul_f32 v172, v13, v172
    v_mul_f32 v173, v13, v173
    v_mul_f32 v174, v13, v174
    ds_read_b64_tr_b16 v[124:125], v21 offset:1024
    ds_read_b64_tr_b16 v[126:127], v21 offset:1536
    s_waitcnt lgkmcnt(8)
    v_mfma_f32_32x32x16_bf16 v[176:191], v[108:111], a[108:111], v[176:191]
    v_mul_f32 v175, v13, v175
    v_cvt_pk_bf16_f32 v160, v160, v161
    v_cvt_pk_bf16_f32 v161, v162, v163
    ds_read_b64_tr_b16 v[96:97], v21 offset:4096
    ds_read_b64_tr_b16 v[98:99], v21 offset:4608
    s_waitcnt lgkmcnt(8)
    v_mfma_f32_32x32x16_bf16 v[176:191], v[112:115], a[112:115], v[176:191]
    buffer_load_dwordx4 v[224:227], v14, s[40:43], s26 offen offset:2048 sc1
    v_cvt_pk_bf16_f32 v162, v164, v165
    v_cvt_pk_bf16_f32 v163, v166, v167
    v_cvt_pk_bf16_f32 v164, v168, v169
    ds_read_b64_tr_b16 v[100:101], v21 offset:5120
    ds_read_b64_tr_b16 v[102:103], v21 offset:5632
    s_waitcnt lgkmcnt(8)
    v_mfma_f32_32x32x16_bf16 v[176:191], v[116:119], a[116:119], v[176:191]
    v_cvt_pk_bf16_f32 v165, v170, v171
    v_cvt_pk_bf16_f32 v166, v172, v173
    v_cvt_pk_bf16_f32 v167, v174, v175
    ds_read_b64_tr_b16 v[104:105], v21 offset:8192
    ds_read_b64_tr_b16 v[106:107], v21 offset:8704
    s_waitcnt lgkmcnt(8)
    v_mfma_f32_32x32x16_bf16 v[176:191], v[120:123], a[120:123], v[176:191]
    buffer_load_dwordx4 v[228:231], v14, s[40:43], s26 offen offset:3072 sc1
    v_pk_max_i16 v160, v160, 0
    v_pk_max_i16 v161, v161, 0
    v_pk_max_i16 v162, v162, 0
    ds_read_b64_tr_b16 v[108:109], v21 offset:9216
    ds_read_b64_tr_b16 v[110:111], v21 offset:9728
    s_waitcnt lgkmcnt(8)
    v_mfma_f32_32x32x16_bf16 v[176:191], v[124:127], a[124:127], v[176:191]
    v_pk_max_i16 v163, v163, 0
    v_pk_max_i16 v164, v164, 0
    v_pk_max_i16 v165, v165, 0
    ds_read_b64_tr_b16 v[112:113], v21 offset:12288
    ds_read_b64_tr_b16 v[114:115], v21 offset:12800
    s_waitcnt lgkmcnt(8)
    v_mfma_f32_32x32x16_bf16 v[176:191], v[96:99], a[128:131], v[176:191]
    buffer_load_dwordx4 v[232:235], v15, s[40:43], s26 offen sc1
    v_pk_max_i16 v166, v166, 0
    v_pk_max_i16 v167, v167, 0
    s_add_u32 s94, s22, 8192
    ds_read_b64_tr_b16 v[116:117], v21 offset:13312
    ds_read_b64_tr_b16 v[118:119], v21 offset:13824
    s_waitcnt lgkmcnt(8)
    v_mfma_f32_32x32x16_bf16 v[176:191], v[100:103], a[132:135], v[176:191]
    buffer_store_dwordx4 v[160:163], v5, s[40:43], s94 offen sc1
    buffer_store_dwordx4 v[164:167], v5, s[40:43], s94 offen offset:512 sc1
    ds_read_b64_tr_b16 v[120:121], v21 offset:16384
    ds_read_b64_tr_b16 v[122:123], v21 offset:16896
    s_waitcnt lgkmcnt(8)
    v_mfma_f32_32x32x16_bf16 v[176:191], v[104:107], a[136:139], v[176:191]
    s_mul_i32 s26, s11, 5120
    s_add_u32 s26, s26, s24
    buffer_load_dwordx4 v[236:239], v14, s[40:43], s26 offen offset:0 sc1
    ds_read_b64_tr_b16 v[124:125], v21 offset:17408
    ds_read_b64_tr_b16 v[126:127], v21 offset:17920
    s_waitcnt lgkmcnt(8)
    v_mfma_f32_32x32x16_bf16 v[176:191], v[108:111], a[140:143], v[176:191]
    s_waitcnt lgkmcnt(6)
    v_mfma_f32_32x32x16_bf16 v[176:191], v[112:115], a[144:147], v[176:191]
    buffer_load_dwordx4 v[240:243], v14, s[40:43], s26 offen offset:1024 sc1
    s_waitcnt lgkmcnt(4)
    v_mfma_f32_32x32x16_bf16 v[176:191], v[116:119], a[148:151], v[176:191]
    s_waitcnt lgkmcnt(2)
    v_mfma_f32_32x32x16_bf16 v[176:191], v[120:123], a[152:155], v[176:191]
    buffer_load_dwordx4 v[244:247], v14, s[40:43], s26 offen offset:2048 sc1
    s_waitcnt lgkmcnt(0)
    v_mfma_f32_32x32x16_bf16 v[176:191], v[124:127], a[156:159], v[176:191]
    buffer_load_dwordx4 v[248:251], v14, s[40:43], s26 offen offset:3072 sc1
    buffer_load_dwordx4 v[252:255], v15, s[40:43], s26 offen sc1
    s_nop 9
    v_mul_f32 v176, v13, v176
    v_mul_f32 v177, v13, v177
    v_mul_f32 v178, v13, v178
    v_mul_f32 v179, v13, v179
    v_mul_f32 v180, v13, v180
    v_mul_f32 v181, v13, v181
    v_mul_f32 v182, v13, v182
    v_mul_f32 v183, v13, v183
    v_mul_f32 v184, v13, v184
    v_mul_f32 v185, v13, v185
    v_mul_f32 v186, v13, v186
    v_mul_f32 v187, v13, v187
    v_mul_f32 v188, v13, v188
    v_mul_f32 v189, v13, v189
    v_mul_f32 v190, v13, v190
    v_mul_f32 v191, v13, v191
    v_cvt_pk_bf16_f32 v176, v176, v177
    v_cvt_pk_bf16_f32 v177, v178, v179
    v_cvt_pk_bf16_f32 v178, v180, v181
    v_cvt_pk_bf16_f32 v179, v182, v183
    v_cvt_pk_bf16_f32 v180, v184, v185
    v_cvt_pk_bf16_f32 v181, v186, v187
    v_cvt_pk_bf16_f32 v182, v188, v189
    v_cvt_pk_bf16_f32 v183, v190, v191
    v_pk_max_i16 v176, v176, 0
    v_pk_max_i16 v177, v177, 0
    v_pk_max_i16 v178, v178, 0
    v_pk_max_i16 v179, v179, 0
    v_pk_max_i16 v180, v180, 0
    v_pk_max_i16 v181, v181, 0
    v_pk_max_i16 v182, v182, 0
    v_pk_max_i16 v183, v183, 0
    s_add_u32 s94, s22, 12288
    buffer_store_dwordx4 v[176:179], v5, s[40:43], s94 offen sc1
    buffer_store_dwordx4 v[180:183], v5, s[40:43], s94 offen offset:512 sc1
    s_mul_i32 s27, s12, 5120
    s_add_u32 s27, s27, s24
    buffer_load_dwordx4 a[0:3], v14, s[40:43], s27 offen offset:0 sc1
    buffer_load_dwordx4 a[4:7], v14, s[40:43], s27 offen offset:1024 sc1
    buffer_load_dwordx4 a[8:11], v14, s[40:43], s27 offen offset:2048 sc1
    buffer_load_dwordx4 a[12:15], v14, s[40:43], s27 offen offset:3072 sc1
    buffer_load_dwordx4 a[16:19], v15, s[40:43], s27 offen sc1
    s_mul_i32 s27, s13, 5120
    s_add_u32 s27, s27, s24
    buffer_load_dwordx4 a[20:23], v14, s[40:43], s27 offen offset:0 sc1
    buffer_load_dwordx4 a[24:27], v14, s[40:43], s27 offen offset:1024 sc1
    buffer_load_dwordx4 a[28:31], v14, s[40:43], s27 offen offset:2048 sc1
    buffer_load_dwordx4 a[32:35], v14, s[40:43], s27 offen offset:3072 sc1
    buffer_load_dwordx4 a[36:39], v15, s[40:43], s27 offen sc1
    s_waitcnt vmcnt(10)
    v_mov_b32 v96, s64
    v_mov_b32 v97, s65
    s_lshl_b32 s90, s67, 2
    s_add_u32 s90, s90, s66
    s_lshl_b32 s90, s90, 4
    s_add_u32 s90, s90, s72
    s_lshl_b32 s90, s90, 3
    s_add_u32 s90, s90, 0x1000
    v_mov_b32 v98, 0
    buffer_store_dwordx2 v[96:97], v98, s[40:43], s90 offen sc1
    s_mul_i32 s27, s14, 5120
    s_add_u32 s27, s27, s24
    buffer_load_dwordx4 a[40:43], v14, s[40:43], s27 offen offset:0 sc1
    buffer_load_dwordx4 a[44:47], v14, s[40:43], s27 offen offset:1024 sc1
    buffer_load_dwordx4 a[48:51], v14, s[40:43], s27 offen offset:2048 sc1
    buffer_load_dwordx4 a[52:55], v14, s[40:43], s27 offen offset:3072 sc1
    buffer_load_dwordx4 a[56:59], v15, s[40:43], s27 offen sc1
    s_mul_i32 s27, s15, 5120
    s_add_u32 s27, s27, s24
    buffer_load_dwordx4 a[60:63], v14, s[40:43], s27 offen offset:0 sc1
    buffer_load_dwordx4 a[64:67], v14, s[40:43], s27 offen offset:1024 sc1
    buffer_load_dwordx4 a[68:71], v14, s[40:43], s27 offen offset:2048 sc1
    buffer_load_dwordx4 a[72:75], v14, s[40:43], s27 offen offset:3072 sc1
    buffer_load_dwordx4 a[76:79], v15, s[40:43], s27 offen sc1
    s_mul_i32 s27, s16, 5120
    s_add_u32 s27, s27, s24
    buffer_load_dwordx4 a[80:83], v14, s[40:43], s27 offen offset:0 sc1
    buffer_load_dwordx4 a[84:87], v14, s[40:43], s27 offen offset:1024 sc1
    buffer_load_dwordx4 a[88:91], v14, s[40:43], s27 offen offset:2048 sc1
    buffer_load_dwordx4 a[92:95], v14, s[40:43], s27 offen offset:3072 sc1
    buffer_load_dwordx4 a[96:99], v15, s[40:43], s27 offen sc1
    s_waitcnt lgkmcnt(0)
    s_branch L_phase2
L_typeB:
    v_add_u32 v20, 40960, v3
    s_mov_b32 s48, s12
    s_and_b32 s49, s13, 0xffff
    s_mov_b32 s50, 0xc8000
    s_mov_b32 s51, 0x20000
    s_add_u32 m0, s4, 0
    s_nop 0
    buffer_load_dwordx4 v48, s[36:39], s76 offen lds
    s_add_u32 m0, s4, 1024
    s_nop 0
    buffer_load_dwordx4 v49, s[36:39], s76 offen lds
    s_add_u32 m0, s4, 2048
    s_nop 0
    buffer_load_dwordx4 v50, s[36:39], s76 offen lds
    s_add_u32 m0, s4, 3072
    s_nop 0
    buffer_load_dwordx4 v51, s[36:39], s76 offen lds
    s_add_u32 m0, s99, 0
    s_nop 0
    buffer_load_dwordx4 v3, s[44:47], s76 offen lds
    s_add_u32 m0, s99, 20480
    s_nop 0
    buffer_load_dwordx4 v3, s[48:51], s76 offen lds
    s_add_u32 m0, s4, 4096
    s_nop 0
    buffer_load_dwordx4 v48, s[36:39], s77 offen lds
    s_add_u32 m0, s4, 5120
    s_nop 0
    buffer_load_dwordx4 v49, s[36:39], s77 offen lds
    s_add_u32 m0, s4, 6144
    s_nop 0
    buffer_load_dwordx4 v50, s[36:39], s77 offen lds
    s_add_u32 m0, s4, 7168
    s_nop 0
    buffer_load_dwordx4 v51, s[36:39], s77 offen lds
    s_add_u32 m0, s99, 4096
    s_nop 0
    buffer_load_dwordx4 v3, s[44:47], s77 offen lds
    s_add_u32 m0, s99, 24576
    s_nop 0
    buffer_load_dwordx4 v3, s[48:51], s77 offen lds
    s_add_u32 s90, s68, 0
    s_lshl_b32 s90, s90, 6
    v_add_u32 v59, s90, v56
    global_load_ushort v21, v59, s[6:7]
    global_load_ushort v22, v59, s[8:9]
    global_load_ushort v32, v59, s[18:19]
    s_add_u32 s90, s68, 1
    s_lshl_b32 s90, s90, 6
    v_add_u32 v59, s90, v56
    global_load_ushort v34, v59, s[6:7]
    global_load_ushort v35, v59, s[8:9]
    global_load_ushort v45, v59, s[18:19]
    s_mov_b32 m0, 147456
    s_nop 0
    buffer_load_dwordx4 v57, s[60:63], 0 offen lds
    s_mov_b32 m0, 148480
    s_nop 0
    buffer_load_dwordx4 v58, s[60:63], 0 offen lds
    v_and_b32 v80, 31, v0
    v_lshrrev_b32 v81, 5, v0
    v_bfe_u32 v83, v80, 2, 1
    v_lshlrev_b32 v83, 4, v83
    v_and_b32 v82, 3, v80
    v_add_u32 v82, v82, v83
    v_lshrrev_b32 v83, 3, v80
    v_lshl_add_u32 v82, v83, 2, v82
    v_bfe_u32 v83, v82, 1, 3
    v_lshlrev_b32 v84, 1, v81
    v_xor_b32 v83, v83, v84
    v_lshlrev_b32 v82, 7, v82
    v_add_u32 v82, s4, v82
    v_xor_b32 v52, 0, v83
    v_lshl_add_u32 v52, v52, 4, v82
    v_xor_b32 v53, 1, v83
    v_lshl_add_u32 v53, v53, 4, v82
    v_xor_b32 v54, 4, v83
    v_lshl_add_u32 v54, v54, 4, v82
    v_xor_b32 v55, 5, v83
    v_lshl_add_u32 v55, v55, 4, v82
    v_lshlrev_b32 v11, 5, v81
    v_add_u32 v11, 147456, v11
    v_bfe_u32 v82, v80, 1, 3
    v_xor_b32 v82, v82, v84
    v_lshlrev_b32 v83, 7, v80
    v_xor_b32 v16, 0, v82
    v_lshl_add_u32 v16, v16, 4, v83
    v_xor_b32 v17, 1, v82
    v_lshl_add_u32 v17, v17, 4, v83
    v_xor_b32 v18, 4, v82
    v_lshl_add_u32 v18, v18, 4, v83
    v_xor_b32 v19, 5, v82
    v_lshl_add_u32 v19, v19, 4, v83
    v_add_u32 v92, 61440, v16
    v_add_u32 v93, 61440, v17
    v_add_u32 v94, 61440, v18
    v_add_u32 v95, 61440, v19
    s_mov_b32 s40, s34
    s_and_b32 s41, s35, 0xffff
    s_mov_b32 s42, 0x10000000
    s_mov_b32 s43, 0x20000
    s_mov_b32 s52, s24
    s_and_b32 s53, s25, 0xffff
    s_mov_b32 s54, 0x1e0000
    s_mov_b32 s55, 0x20000
    s_mov_b32 s56, s26
    s_and_b32 s57, s27, 0xffff
    s_mov_b32 s58, 0x1e0000
    s_mov_b32 s59, 0x20000
    s_lshl_b32 s90, s75, 3
    s_add_u32 s90, s90, s66
    s_mul_i32 s90, s90, 24576
    s_lshl_b32 s91, s69, 8
    s_add_u32 s28, s90, s91
    v_lshrrev_b32 v59, 1, v0
    v_mul_u32_u24 v59, 1280, v59
    v_and_b32 v84, 1, v0
    v_lshl_add_u32 v59, v84, 4, v59
    s_lshl_b32 s90, s2, 2
    s_add_u32 s98, s90, s66
    s_cmp_lt_u32 s98, 960
    s_cselect_b32 s91, 0, 0x40000000
    v_add_u32 v59, s91, v59
    v_lshlrev_b32 v14, 4, v0
    v_add_u32 v1, s91, v14
    s_min_u32 s91, s98, 959
    s_lshl_b32 s91, s91, 1
    s_mul_hi_u32 s90, s91, 0x1111112
    s_mul_i32 s94, s90, 240
    s_sub_u32 s91, s91, s94
    s_mul_i32 s94, s90, 440
    s_add_u32 s94, s94, s91
    s_lshl_b32 s94, s94, 10
    s_add_u32 s26, s94, 0x40000
    s_mul_hi_u32 s94, s91, 0x33333334
    s_mul_i32 s95, s94, 5
    s_sub_u32 s95, s91, s95
    s_mul_i32 s94, s94, 40960
    s_mul_i32 s96, s90, 160
    s_add_u32 s94, s94, s96
    s_lshl_b32 s95, s95, 5
    s_add_u32 s27, s94, s95
    s_add_u32 s91, s91, 1
    s_mul_hi_u32 s94, s91, 0x33333334
    s_mul_i32 s95, s94, 5
    s_sub_u32 s95, s91, s95
    s_mul_i32 s94, s94, 40960
    s_mul_i32 s96, s90, 160
    s_add_u32 s94, s94, s96
    s_lshl_b32 s95, s95, 5
    s_add_u32 s29, s94, s95
    v_lshrrev_b32 v85, 5, v0
    v_lshlrev_b32 v85, 4, v85
    v_bfe_u32 v86, v0, 4, 1
    v_lshl_add_u32 v85, v86, 2, v85
    v_bfe_u32 v86, v0, 2, 2
    v_add_u32 v85, v85, v86
    v_lshlrev_b32 v85, 5, v85
    v_and_b32 v86, 3, v0
    v_lshl_add_u32 v85, v86, 3, v85
    s_add_u32 s97, s99, 53248
    v_add_u32 v15, s97, v85
    s_add_u32 s97, s99, 73728
    v_and_b32 v85, 15, v0
    v_lshrrev_b32 v86, 4, v0
    v_lshrrev_b32 v87, 1, v85
    v_xor_b32 v86, v86, v87
    v_lshlrev_b32 v86, 4, v86
    v_xor_b32 v87, 64, v86
    v_and_b32 v89, 7, v85
    v_lshrrev_b32 v85, 3, v85
    v_lshlrev_b32 v85, 12, v85
    v_lshl_add_u32 v85, v89, 7, v85
    v_add_u32 v85, s97, v85
    v_add_u32 v62, v86, v85
    v_add_u32 v63, v87, v85
    s_cmp_lt_u32 s98, 800
    s_cselect_b32 s91, 0, 0x40000000
    v_add_u32 v60, s91, v60
    v_add_u32 v61, s91, v61
    v_add_u32 v2, s91, v14
    s_min_u32 s91, s98, 799
    s_cmp_ge_u32 s91, 400
    s_cselect_b32 s90, 1, 0
    s_cselect_b32 s60, s16, s14
    s_cselect_b32 s61, s17, s15
    s_and_b32 s61, s61, 0xffff
    s_mov_b32 s62, 819200
    s_mov_b32 s63, 0x20000
    s_mul_i32 s94, s90, 400
    s_sub_u32 s91, s91, s94
    s_mul_hi_u32 s94, s91, 0x51eb852
    s_mul_i32 s95, s94, 50
    s_sub_u32 s91, s91, s95
    s_mul_hi_u32 s95, s91, 0x33333334
    s_mul_i32 s96, s95, 5
    s_sub_u32 s96, s91, s96
    s_mul_i32 s97, s94, 80
    s_lshl_b32 s91, s96, 4
    s_add_u32 s97, s97, s91
    s_mul_i32 s97, s97, 1280
    s_lshl_b32 s91, s95, 7
    s_add_u32 s24, s97, s91
    s_mul_i32 s90, s90, 20
    s_lshl_b32 s95, s95, 1
    s_add_u32 s90, s90, s95
    s_add_u32 s90, s90, 48
    s_mul_i32 s94, s94, 88
    s_add_u32 s90, s90, s94
    s_mul_i32 s90, s90, 5
    s_add_u32 s90, s90, s96
    s_lshl_b32 s90, s90, 10
    s_add_u32 s25, s90, 0x40000
    s_add_u32 m0, s4, 8192
    s_nop 0
    buffer_load_dwordx4 v48, s[36:39], s78 offen lds
    s_add_u32 m0, s4, 9216
    s_nop 0
    buffer_load_dwordx4 v49, s[36:39], s78 offen lds
    s_add_u32 m0, s4, 10240
    s_nop 0
    buffer_load_dwordx4 v50, s[36:39], s78 offen lds
    s_add_u32 m0, s4, 11264
    s_nop 0
    buffer_load_dwordx4 v51, s[36:39], s78 offen lds
    s_add_u32 m0, s99, 8192
    s_nop 0
    buffer_load_dwordx4 v3, s[44:47], s78 offen lds
    s_add_u32 m0, s99, 28672
    s_nop 0
    buffer_load_dwordx4 v3, s[48:51], s78 offen lds
    s_add_u32 m0, s4, 12288
    s_nop 0
    buffer_load_dwordx4 v48, s[36:39], s79 offen lds
    s_add_u32 m0, s4, 13312
    s_nop 0
    buffer_load_dwordx4 v49, s[36:39], s79 offen lds
    s_add_u32 m0, s4, 14336
    s_nop 0
    buffer_load_dwordx4 v50, s[36:39], s79 offen lds
    s_add_u32 m0, s4, 15360
    s_nop 0
    buffer_load_dwordx4 v51, s[36:39], s79 offen lds
    s_add_u32 m0, s99, 12288
    s_nop 0
    buffer_load_dwordx4 v3, s[44:47], s79 offen lds
    s_add_u32 m0, s99, 32768
    s_nop 0
    buffer_load_dwordx4 v3, s[48:51], s79 offen lds
    s_waitcnt vmcnt(12)
    ds_read_b128 a[160:163], v11 offset:0
    ds_read_b128 a[164:167], v11 offset:16
    ds_read_b128 a[168:171], v11 offset:64
    ds_read_b128 a[172:175], v11 offset:80
    ds_read_b128 a[176:179], v11 offset:128
    ds_read_b128 a[180:183], v11 offset:144
    ds_read_b128 a[184:187], v11 offset:192
    ds_read_b128 a[188:191], v11 offset:208
    ds_read_b128 a[192:195], v11 offset:256
    ds_read_b128 a[196:199], v11 offset:272
    ds_read_b128 a[200:203], v11 offset:320
    ds_read_b128 a[204:207], v11 offset:336
    ds_read_b128 a[208:211], v11 offset:384
    ds_read_b128 a[212:215], v11 offset:400
    ds_read_b128 a[216:219], v11 offset:448
    ds_read_b128 a[220:223], v11 offset:464
    ds_read_b128 a[224:227], v11 offset:512
    ds_read_b128 a[228:231], v11 offset:528
    ds_read_b128 a[232:235], v11 offset:576
    ds_read_b128 a[236:239], v11 offset:592
    ds_read_b128 a[0:3], v52 offset:0
    ds_read_b128 a[4:7], v53 offset:0
    ds_read_b128 a[8:11], v54 offset:0
    ds_read_b128 a[12:15], v55 offset:0
    s_barrier
    ds_read_b128 v[96:99], v16 offset:0
    ds_read_b128 v[100:103], v16 offset:20480
    ds_read_b128 v[104:107], v17 offset:0
    ds_read_b128 v[108:111], v17 offset:20480
    ds_read_b128 v[112:115], v18 offset:0
    ds_read_b128 v[116:119], v18 offset:20480
    s_waitcnt lgkmcnt(0)
    v_mfma_f32_32x32x16_bf16 v[128:143], a[0:3], v[96:99], 0
    ds_read_b128 a[16:19], v52 offset:4096
    ds_read_b128 a[20:23], v53 offset:4096
    ds_read_b128 a[24:27], v54 offset:4096
    ds_read_b128 a[28:31], v55 offset:4096
    s_add_u32 m0, s4, 0
    s_nop 0
    buffer_load_dwordx4 v48, s[36:39], s80 offen lds
    s_add_u32 m0, s4, 1024
    s_nop 0
    buffer_load_dwordx4 v49, s[36:39], s80 offen lds
    v_mfma_f32_32x32x16_bf16 v[144:159], a[0:3], v[100:103], 0
    ds_read_b128 v[120:123], v19 offset:0
    ds_read_b128 v[124:127], v19 offset:20480
    v_mfma_f32_32x32x16_bf16 v[160:175], a[160:163], a[0:3], 0
    v_and_b32 v80, 31, v0
    v_lshrrev_b32 v81, 5, v0
    v_lshrrev_b32 v82, 4, v80
    v_mfma_f32_32x32x16_bf16 v[128:143], a[4:7], v[104:107], v[128:143]
    v_lshlrev_b32 v82, 10, v82
    v_and_b32 v83, 15, v80
    v_lshl_add_u32 v83, v81, 4, v83
    s_waitcnt lgkmcnt(2)
    s_add_u32 m0, s4, 4096
    s_nop 0
    buffer_load_dwordx4 v48, s[36:39], s81 offen lds
    s_add_u32 m0, s99, 16384
    s_nop 0
    buffer_load_dwordx4 v3, s[44:47], s80 offen lds
    s_add_u32 m0, s4, 2048
    s_nop 0
    buffer_load_dwordx4 v50, s[36:39], s80 offen lds
    s_add_u32 m0, s4, 3072
    s_nop 0
    buffer_load_dwordx4 v51, s[36:39], s80 offen lds
    ds_read_b128 a[160:163], v11 offset:640
    v_mfma_f32_32x32x16_bf16 v[144:159], a[4:7], v[108:111], v[144:159]
    v_lshl_add_u32 v5, v83, 4, v82
    v_lshlrev_b32 v6, 4, v80
    v_mul_u32_u24 v10, 80, v80
    s_barrier
    ds_read_b128 v[96:99], v16 offset:4096
    ds_read_b128 v[100:103], v16 offset:24576
    v_mfma_f32_32x32x16_bf16 v[160:175], a[164:167], a[4:7], v[160:175]
    v_add_u32 v10, 143360, v10
    s_lshl_b32 s95, s66, 1
    v_add_u32 v88, s95, v81
    v_mfma_f32_32x32x16_bf16 v[128:143], a[8:11], v[112:115], v[128:143]
    v_lshl_add_u32 v9, v88, 3, v10
    v_add_u32 v83, 0, v88
    v_sub_u32 v89, s67, v83
    s_add_u32 m0, s4, 5120
    s_nop 0
    buffer_load_dwordx4 v49, s[36:39], s81 offen lds
    s_add_u32 m0, s99, 53248
    s_nop 0
    buffer_load_dwordx4 v59, s[56:59], s27 offen lds
    ds_read_b128 a[164:167], v11 offset:656
    v_mfma_f32_32x32x16_bf16 v[144:159], a[8:11], v[116:119], v[144:159]
    v_add_u32 v89, -1, v89
    v_cmp_gt_u32 vcc, s67, v83
    s_nop 1
    v_cndmask_b32 v89, -1, v89, vcc
    v_cndmask_b32 v83, 0, v83, vcc
    ds_read_b128 v[104:107], v17 offset:4096
    ds_read_b128 v[108:111], v17 offset:24576
    v_mfma_f32_32x32x16_bf16 v[160:175], a[168:171], a[8:11], v[160:175]
    v_lshl_add_u32 v7, v83, 9, v6
    v_add_u32 v83, 8, v88
    s_waitcnt lgkmcnt(7)
    v_mfma_f32_32x32x16_bf16 v[128:143], a[12:15], v[120:123], v[128:143]
    v_sub_u32 v90, s67, v83
    v_add_u32 v90, -1, v90
    v_cmp_gt_u32 vcc, s67, v83
    s_nop 1
    v_cndmask_b32 v90, -1, v90, vcc
    v_cndmask_b32 v83, 0, v83, vcc
    s_add_u32 m0, s4, 6144
    s_nop 0
    buffer_load_dwordx4 v50, s[36:39], s81 offen lds
    s_add_u32 m0, s99, 36864
    s_nop 0
    buffer_load_dwordx4 v3, s[48:51], s80 offen lds
    s_add_u32 m0, s99, 57344
    s_nop 0
    buffer_load_dwordx4 v59, s[56:59], s29 offen lds
    ds_read_b128 a[168:171], v11 offset:704
    s_waitcnt lgkmcnt(7)
    v_mfma_f32_32x32x16_bf16 v[144:159], a[12:15], v[124:127], v[144:159]
    v_lshl_add_u32 v8, v83, 9, v6
    s_lshr_b32 s90, s66, 1
    s_lshl_b32 s91, s67, 1
    ds_read_b128 v[112:115], v18 offset:4096
    ds_read_b128 v[116:119], v18 offset:24576
    v_mfma_f32_32x32x16_bf16 v[160:175], a[172:175], a[12:15], v[160:175]
    s_add_u32 s90, s90, s91
    s_mul_i32 s90, s90, 360448
    s_and_b32 s91, s66, 1
    s_waitcnt lgkmcnt(7)
    v_mfma_f32_32x32x16_bf16 v[128:143], a[16:19], v[96:99], v[128:143]
    s_lshl_b32 s91, s91, 11
    s_add_u32 s90, s90, s91
    s_add_u32 s90, s90, 0x400000
    s_add_u32 m0, s4, 7168
    s_nop 0
    buffer_load_dwordx4 v51, s[36:39], s81 offen lds
    s_waitcnt vmcnt(20)
    ds_read_b128 a[32:35], v52 offset:8192
    ds_read_b128 a[36:39], v53 offset:8192
    ds_read_b128 a[40:43], v54 offset:8192
    ds_read_b128 a[44:47], v55 offset:8192
    s_add_u32 m0, s99, 73728
    s_nop 0
    buffer_load_dwordx4 v60, s[60:63], s24 offen lds
    ds_read_b128 a[172:175], v11 offset:720
    s_waitcnt lgkmcnt(11)
    v_mfma_f32_32x32x16_bf16 v[144:159], a[16:19], v[100:103], v[144:159]
    s_lshl_b32 s91, s69, 14
    s_add_u32 s22, s90, s91
    s_lshl_b32 s91, s68, 12
    ds_read_b128 v[120:123], v19 offset:4096
    ds_read_b128 v[124:127], v19 offset:24576
    v_mfma_f32_32x32x16_bf16 v[160:175], a[176:179], a[16:19], v[160:175]
    s_add_u32 s23, s90, s91
    s_add_u32 s64, s3, 1
    s_xor_b32 s65, s64, 0x5bd1e995
    s_waitcnt lgkmcnt(11)
    v_mfma_f32_32x32x16_bf16 v[128:143], a[20:23], v[104:107], v[128:143]
    v_lshlrev_b32 v80, 16, v21
    v_lshlrev_b32 v81, 16, v22
    v_lshlrev_b32 v82, 16, v32
    s_waitcnt lgkmcnt(3)
    s_add_u32 m0, s4, 8192
    s_nop 0
    buffer_load_dwordx4 v48, s[36:39], s82 offen lds
    s_add_u32 m0, s99, 40960
    s_nop 0
    buffer_load_dwordx4 v3, s[44:47], s81 offen lds
    s_add_u32 m0, s99, 77824
    s_nop 0
    buffer_load_dwordx4 v61, s[60:63], s24 offen lds
    ds_read_b128 a[176:179], v11 offset:768
    v_mfma_f32_32x32x16_bf16 v[144:159], a[20:23], v[108:111], v[144:159]
    v_mul_f32 v82, 0x3fb8aa3b, v82
    v_exp_f32 v82, v82
    s_nop 0
    v_cvt_pk_bf16_f32 v82, v82, v82
    s_waitcnt vmcnt(22)
    s_barrier
    ds_read_b128 v[96:99], v16 offset:8192
    ds_read_b128 v[100:103], v16 offset:28672
    v_mfma_f32_32x32x16_bf16 v[160:175], a[180:183], a[20:23], v[160:175]
    v_lshlrev_b32 v82, 16, v82
    v_mul_f32 v83, v82, v80
    v_mul_f32 v84, v82, v81
    v_mfma_f32_32x32x16_bf16 v[128:143], a[24:27], v[112:115], v[128:143]
    v_mul_f32 v83, 0x3fb8aa3b, v83
    v_mul_f32 v84, 0x3e22f983, v84
    v_mul_f32 v82, 0x3f800000, v83
    s_add_u32 m0, s4, 9216
    s_nop 0
    buffer_load_dwordx4 v49, s[36:39], s82 offen lds
    ds_read_b128 a[180:183], v11 offset:784
    v_mfma_f32_32x32x16_bf16 v[144:159], a[24:27], v[116:119], v[144:159]
    v_mul_f32 v85, 0x3f800000, v84
    v_exp_f32 v82, v82
    v_fract_f32 v85, v85
    ds_read_b128 v[104:107], v17 offset:8192
    ds_read_b128 v[108:111], v17 offset:28672
    v_mfma_f32_32x32x16_bf16 v[160:175], a[184:187], a[24:27], v[160:175]
    v_cos_f32 v21, v85
    v_sin_f32 v22, v85
    v_mul_f32 v21, v82, v21
    s_waitcnt lgkmcnt(7)
    v_mfma_f32_32x32x16_bf16 v[128:143], a[28:31], v[120:123], v[128:143]
    v_mul_f32 v22, v82, v22
    v_sub_f32 v23, 0, v22
    v_mul_f32 v82, 0x41800000, v83
    s_add_u32 m0, s4, 10240
    s_nop 0
    buffer_load_dwordx4 v50, s[36:39], s82 offen lds
    s_add_u32 m0, s99, 61440
    s_nop 0
    buffer_load_dwordx4 v3, s[48:51], s81 offen lds
    ds_read_b128 a[184:187], v11 offset:832
    s_waitcnt lgkmcnt(7)
    v_mfma_f32_32x32x16_bf16 v[144:159], a[28:31], v[124:127], v[144:159]
    v_mul_f32 v85, 0x41800000, v84
    v_exp_f32 v82, v82
    v_fract_f32 v85, v85
    ds_read_b128 v[112:115], v18 offset:8192
    ds_read_b128 v[116:119], v18 offset:28672
    v_mfma_f32_32x32x16_bf16 v[160:175], a[188:191], a[28:31], v[160:175]
    v_cos_f32 v24, v85
    v_sin_f32 v25, v85
    v_mul_f32 v24, v82, v24
    s_waitcnt lgkmcnt(7)
    v_mfma_f32_32x32x16_bf16 v[128:143], a[32:35], v[96:99], v[128:143]
    v_mul_f32 v25, v82, v25
    v_cvt_f32_u32 v86, v88
    v_mul_f32 v86, 0x41800000, v86
    s_add_u32 m0, s4, 11264
    s_nop 0
    buffer_load_dwordx4 v51, s[36:39], s82 offen lds
    s_waitcnt vmcnt(22)
    ds_read_b128 a[48:51], v52 offset:12288
    ds_read_b128 a[52:55], v53 offset:12288
    ds_read_b128 a[56:59], v54 offset:12288
    ds_read_b128 a[60:63], v55 offset:12288
    ds_read_b128 a[188:191], v11 offset:848
    s_waitcnt lgkmcnt(11)
    v_mfma_f32_32x32x16_bf16 v[144:159], a[32:35], v[100:103], v[144:159]
    v_mul_f32 v82, v86, v83
    v_mul_f32 v85, v86, v84
    v_exp_f32 v82, v82
    ds_read_b128 v[120:123], v19 offset:8192
    ds_read_b128 v[124:127], v19 offset:28672
    v_mfma_f32_32x32x16_bf16 v[160:175], a[192:195], a[32:35], v[160:175]
    v_fract_f32 v85, v85
    v_cos_f32 v26, v85
    v_sin_f32 v27, v85
    s_waitcnt lgkmcnt(11)
    v_mfma_f32_32x32x16_bf16 v[128:143], a[36:39], v[104:107], v[128:143]
    v_mul_f32 v26, v82, v26
    v_mul_f32 v27, v82, v27
    v_cvt_f32_i32 v86, v89
    s_waitcnt lgkmcnt(3)
    s_add_u32 m0, s4, 12288
    s_nop 0
    buffer_load_dwordx4 v48, s[36:39], s83 offen lds
    s_add_u32 m0, s99, 45056
    s_nop 0
    buffer_load_dwordx4 v3, s[44:47], s82 offen lds
    ds_read_b128 a[192:195], v11 offset:896
    v_mfma_f32_32x32x16_bf16 v[144:159], a[36:39], v[108:111], v[144:159]
    v_mul_f32 v86, 0x43000000, v86
    v_mul_f32 v82, v86, v83
    v_mul_f32 v85, v86, v84
    s_waitcnt vmcnt(22)
    s_barrier
    ds_read_b128 v[96:99], v16 offset:12288
    ds_read_b128 v[100:103], v16 offset:32768
    v_mfma_f32_32x32x16_bf16 v[160:175], a[196:199], a[36:39], v[160:175]
    v_exp_f32 v82, v82
    v_fract_f32 v85, v85
    v_cos_f32 v28, v85
    v_mfma_f32_32x32x16_bf16 v[128:143], a[40:43], v[112:115], v[128:143]
    v_sin_f32 v29, v85
    v_mul_f32 v28, v82, v28
    v_mul_f32 v29, v82, v29
    s_add_u32 m0, s4, 13312
    s_nop 0
    buffer_load_dwordx4 v49, s[36:39], s83 offen lds
    ds_read_b128 a[196:199], v11 offset:912
    v_mfma_f32_32x32x16_bf16 v[144:159], a[40:43], v[116:119], v[144:159]
    v_cmp_le_i32 vcc, 0, v89
    s_nop 1
    v_cndmask_b32 v28, 0, v28, vcc
    v_cndmask_b32 v29, 0, v29, vcc
    ds_read_b128 v[104:107], v17 offset:12288
    ds_read_b128 v[108:111], v17 offset:32768
    v_mfma_f32_32x32x16_bf16 v[160:175], a[200:203], a[40:43], v[160:175]
    v_cvt_f32_i32 v86, v90
    v_mul_f32 v86, 0x43000000, v86
    v_mul_f32 v82, v86, v83
    s_waitcnt lgkmcnt(7)
    v_mfma_f32_32x32x16_bf16 v[128:143], a[44:47], v[120:123], v[128:143]
    s_waitcnt vmcnt(12)
    ds_read_b64_tr_b16 v[64:65], v15 offset:0
    v_mul_f32 v85, v86, v84
    v_exp_f32 v82, v82
    s_add_u32 m0, s4, 14336
    s_nop 0
    buffer_load_dwordx4 v50, s[36:39], s83 offen lds
    s_add_u32 m0, s99, 65536
    s_nop 0
    buffer_load_dwordx4 v3, s[48:51], s82 offen lds
    ds_read_b128 a[200:203], v11 offset:960
    s_waitcnt lgkmcnt(8)
    v_mfma_f32_32x32x16_bf16 v[144:159], a[44:47], v[124:127], v[144:159]
    v_fract_f32 v85, v85
    v_cos_f32 v30, v85
    v_sin_f32 v31, v85
    ds_read_b128 v[112:115], v18 offset:12288
    ds_read_b128 v[116:119], v18 offset:32768
    v_mfma_f32_32x32x16_bf16 v[160:175], a[204:207], a[44:47], v[160:175]
    ds_read_b64_tr_b16 v[66:67], v15 offset:256
    v_mul_f32 v30, v82, v30
    v_mul_f32 v31, v82, v31
    s_waitcnt lgkmcnt(9)
    v_mfma_f32_32x32x16_bf16 v[128:143], a[48:51], v[96:99], v[128:143]
    v_cmp_le_i32 vcc, 0, v90
    s_nop 1
    v_cndmask_b32 v30, 0, v30, vcc
    v_cndmask_b32 v31, 0, v31, vcc
    s_add_u32 m0, s4, 15360
    s_nop 0
    buffer_load_dwordx4 v51, s[36:39], s83 offen lds
    ds_read_b128 a[64:67], v52 offset:0
    ds_read_b128 a[68:71], v53 offset:0
    ds_read_b128 a[72:75], v54 offset:0
    ds_read_b128 a[76:79], v55 offset:0
    ds_read_b128 a[204:207], v11 offset:976
    s_waitcnt lgkmcnt(13)
    v_mfma_f32_32x32x16_bf16 v[144:159], a[48:51], v[100:103], v[144:159]
    ds_read_b64_tr_b16 v[68:69], v15 offset:4096
    v_add_f32 v82, -1.0, v21
    v_mul_f32 v83, v80, v80
    ds_read_b128 v[120:123], v19 offset:12288
    ds_read_b128 v[124:127], v19 offset:32768
    v_mfma_f32_32x32x16_bf16 v[160:175], a[208:211], a[48:51], v[160:175]
    v_fmac_f32 v83, v81, v81
    v_rcp_f32 v83, v83
    v_mul_f32 v84, v82, v80
    s_waitcnt lgkmcnt(14)
    v_mfma_f32_32x32x16_bf16 v[128:143], a[52:55], v[104:107], v[128:143]
    ds_read_b64_tr_b16 v[70:71], v15 offset:4352
    v_fmac_f32 v84, v22, v81
    v_mul_f32 v85, v22, v80
    s_waitcnt lgkmcnt(5)
    s_add_u32 m0, s4, 0
    s_nop 0
    buffer_load_dwordx4 v48, s[36:39], s84 offen lds
    s_add_u32 m0, s99, 49152
    s_nop 0
    buffer_load_dwordx4 v3, s[44:47], s83 offen lds
    ds_read_b128 a[208:211], v11 offset:1024
    v_mfma_f32_32x32x16_bf16 v[144:159], a[52:55], v[108:111], v[144:159]
    v_fma_f32 v85, -v82, v81, v85
    v_add_f32 v83, v83, v83
    v_mul_f32 v32, v84, v83
    s_barrier
    ds_read_b128 v[96:99], v16 offset:16384
    ds_read_b128 v[100:103], v16 offset:36864
    v_mfma_f32_32x32x16_bf16 v[160:175], a[212:215], a[52:55], v[160:175]
    s_waitcnt vmcnt(12)
    ds_read_b128 v[72:75], v62
    v_mul_f32 v33, v85, v83
    v_lshlrev_b32 v80, 16, v34
    v_mfma_f32_32x32x16_bf16 v[128:143], a[56:59], v[112:115], v[128:143]
    v_lshlrev_b32 v81, 16, v35
    v_lshlrev_b32 v82, 16, v45
    v_mul_f32 v82, 0x3fb8aa3b, v82
    s_add_u32 m0, s4, 1024
    s_nop 0
    buffer_load_dwordx4 v49, s[36:39], s84 offen lds
    ds_read_b128 a[212:215], v11 offset:1040
    v_mfma_f32_32x32x16_bf16 v[144:159], a[56:59], v[116:119], v[144:159]
    ds_read_b128 v[76:79], v63
    v_exp_f32 v82, v82
    s_nop 0
    v_cvt_pk_bf16_f32 v82, v82, v82
    ds_read_b128 v[104:107], v17 offset:16384
    ds_read_b128 v[108:111], v17 offset:36864
    v_mfma_f32_32x32x16_bf16 v[160:175], a[216:219], a[56:59], v[160:175]
    v_lshlrev_b32 v82, 16, v82
    v_mul_f32 v83, v82, v80
    v_mul_f32 v84, v82, v81
    s_waitcnt lgkmcnt(10)
    v_mfma_f32_32x32x16_bf16 v[128:143], a[60:63], v[120:123], v[128:143]
    v_mul_f32 v83, 0x3fb8aa3b, v83
    v_mul_f32 v84, 0x3e22f983, v84
    v_mul_f32 v82, 0x3f800000, v83
    s_add_u32 m0, s4, 2048
    s_nop 0
    buffer_load_dwordx4 v50, s[36:39], s84 offen lds
    s_add_u32 m0, s99, 69632
    s_nop 0
    buffer_load_dwordx4 v3, s[48:51], s83 offen lds
    ds_read_b128 a[216:219], v11 offset:1088
    s_waitcnt lgkmcnt(10)
    v_mfma_f32_32x32x16_bf16 v[144:159], a[60:63], v[124:127], v[144:159]
    v_mul_f32 v85, 0x3f800000, v84
    v_exp_f32 v82, v82
    v_fract_f32 v85, v85
    ds_read_b128 v[112:115], v18 offset:16384
    ds_read_b128 v[116:119], v18 offset:36864
    v_mfma_f32_32x32x16_bf16 v[160:175], a[220:223], a[60:63], v[160:175]
    v_cos_f32 v34, v85
    v_sin_f32 v35, v85
    v_mul_f32 v34, v82, v34
    s_waitcnt lgkmcnt(9)
    v_mfma_f32_32x32x16_bf16 v[128:143], a[64:67], v[96:99], v[128:143]
    v_mul_f32 v35, v82, v35
    v_sub_f32 v36, 0, v35
    v_mul_f32 v82, 0x41800000, v83
    s_add_u32 m0, s4, 3072
    s_nop 0
    buffer_load_dwordx4 v51, s[36:39], s84 offen lds
    ds_read_b128 a[80:83], v52 offset:4096
    ds_read_b128 a[84:87], v53 offset:4096
    ds_read_b128 a[88:91], v54 offset:4096
    ds_read_b128 a[92:95], v55 offset:4096
    ds_read_b128 a[220:223], v11 offset:1104
    s_waitcnt lgkmcnt(13)
    v_mfma_f32_32x32x16_bf16 v[144:159], a[64:67], v[100:103], v[144:159]
    v_mul_f32 v85, 0x41800000, v84
    v_exp_f32 v82, v82
    v_fract_f32 v85, v85
    ds_read_b128 v[120:123], v19 offset:16384
    ds_read_b128 v[124:127], v19 offset:36864
    v_mfma_f32_32x32x16_bf16 v[160:175], a[224:227], a[64:67], v[160:175]
    v_cos_f32 v37, v85
    v_sin_f32 v38, v85
    v_mul_f32 v37, v82, v37
    s_waitcnt lgkmcnt(11)
    v_mfma_f32_32x32x16_bf16 v[128:143], a[68:71], v[104:107], v[128:143]
    v_mul_f32 v38, v82, v38
    v_cvt_f32_u32 v86, v88
    v_mul_f32 v86, 0x41800000, v86
    s_waitcnt lgkmcnt(3)
    s_add_u32 m0, s4, 4096
    s_nop 0
    buffer_load_dwordx4 v48, s[36:39], s85 offen lds
    s_add_u32 m0, s99, 53248
    s_nop 0
    buffer_load_dwordx4 v3, s[44:47], s84 offen lds
    ds_read_b128 a[224:227], v11 offset:1152
    v_mfma_f32_32x32x16_bf16 v[144:159], a[68:71], v[108:111], v[144:159]
    v_mul_f32 v82, v86, v83
    v_mul_f32 v85, v86, v84
    v_exp_f32 v82, v82
    s_waitcnt vmcnt(15)
    s_barrier
    ds_read_b128 v[96:99], v16 offset:40960
    ds_read_b128 v[100:103], v92 offset:0
    v_mfma_f32_32x32x16_bf16 v[160:175], a[228:231], a[68:71], v[160:175]
    v_fract_f32 v85, v85
    v_cos_f32 v39, v85
    v_sin_f32 v40, v85
    v_mfma_f32_32x32x16_bf16 v[128:143], a[72:75], v[112:115], v[128:143]
    v_mul_f32 v39, v82, v39
    v_mul_f32 v40, v82, v40
    v_cvt_f32_i32 v86, v89
    s_add_u32 m0, s4, 5120
    s_nop 0
    buffer_load_dwordx4 v49, s[36:39], s85 offen lds
    ds_read_b128 a[228:231], v11 offset:1168
    v_mfma_f32_32x32x16_bf16 v[144:159], a[72:75], v[116:119], v[144:159]
    v_mul_f32 v86, 0x43000000, v86
    v_mul_f32 v82, v86, v83
    v_mul_f32 v85, v86, v84
    ds_read_b128 v[104:107], v17 offset:40960
    ds_read_b128 v[108:111], v93 offset:0
    v_mfma_f32_32x32x16_bf16 v[160:175], a[232:235], a[72:75], v[160:175]
    v_exp_f32 v82, v82
    v_fract_f32 v85, v85
    v_cos_f32 v41, v85
    s_waitcnt lgkmcnt(7)
    v_mfma_f32_32x32x16_bf16 v[128:143], a[76:79], v[120:123], v[128:143]
    v_sin_f32 v42, v85
    v_mul_f32 v41, v82, v41
    v_mul_f32 v42, v82, v42
    s_add_u32 m0, s4, 6144
    s_nop 0
    buffer_load_dwordx4 v50, s[36:39], s85 offen lds
    s_add_u32 m0, s99, 73728
    s_nop 0
    buffer_load_dwordx4 v3, s[48:51], s84 offen lds
    ds_read_b128 a[232:235], v11 offset:1216
    s_waitcnt lgkmcnt(7)
    v_mfma_f32_32x32x16_bf16 v[144:159], a[76:79], v[124:127], v[144:159]
    v_cmp_le_i32 vcc, 0, v89
    s_nop 1
    v_cndmask_b32 v41, 0, v41, vcc
    v_cndmask_b32 v42, 0, v42, vcc
    ds_read_b128 v[112:115], v18 offset:40960
    ds_read_b128 v[116:119], v94 offset:0
    v_mfma_f32_32x32x16_bf16 v[160:175], a[236:239], a[76:79], v[160:175]
    v_cvt_f32_i32 v86, v90
    v_mul_f32 v86, 0x43000000, v86
    v_mul_f32 v82, v86, v83
    s_waitcnt lgkmcnt(7)
    v_mfma_f32_32x32x16_bf16 v[128:143], a[80:83], v[96:99], v[128:143]
    v_mul_f32 v85, v86, v84
    v_exp_f32 v82, v82
    v_fract_f32 v85, v85
    s_add_u32 m0, s4, 7168
    s_nop 0
    buffer_load_dwordx4 v51, s[36:39], s85 offen lds
    s_waitcnt vmcnt(18)
    ds_read_b128 a[96:99], v52 offset:8192
    ds_read_b128 a[100:103], v53 offset:8192
    ds_read_b128 a[104:107], v54 offset:8192
    ds_read_b128 a[108:111], v55 offset:8192
    ds_read_b128 a[236:239], v11 offset:1232
    s_waitcnt lgkmcnt(11)
    v_mfma_f32_32x32x16_bf16 v[144:159], a[80:83], v[100:103], v[144:159]
    v_cos_f32 v43, v85
    v_sin_f32 v44, v85
    v_mul_f32 v43, v82, v43
    ds_read_b128 v[120:123], v19 offset:40960
    ds_read_b128 v[124:127], v95 offset:0
    v_mfma_f32_32x32x16_bf16 v[160:175], a[160:163], a[80:83], v[160:175]
    v_mul_f32 v44, v82, v44
    v_cmp_le_i32 vcc, 0, v90
    s_nop 1
    v_cndmask_b32 v43, 0, v43, vcc
    v_cndmask_b32 v44, 0, v44, vcc
    s_waitcnt lgkmcnt(11)
    v_mfma_f32_32x32x16_bf16 v[128:143], a[84:87], v[104:107], v[128:143]
    v_add_f32 v82, -1.0, v34
    v_mul_f32 v83, v80, v80
    s_add_u32 m0, s99, 57344
    s_nop 0
    buffer_load_dwordx4 v3, s[44:47], s85 offen lds
    s_waitcnt lgkmcnt(10)
    v_mfma_f32_32x32x16_bf16 v[144:159], a[84:87], v[108:111], v[144:159]
    v_fmac_f32 v83, v81, v81
    v_rcp_f32 v83, v83
    v_mul_f32 v84, v82, v80
    s_waitcnt vmcnt(14)
    s_barrier
    ds_read_b128 v[96:99], v16 offset:45056
    ds_read_b128 v[100:103], v92 offset:4096
    v_mfma_f32_32x32x16_bf16 v[160:175], a[164:167], a[84:87], v[160:175]
    v_fmac_f32 v84, v35, v81
    v_mul_f32 v85, v35, v80
    v_fma_f32 v85, -v82, v81, v85
    s_waitcnt lgkmcnt(10)
    v_mfma_f32_32x32x16_bf16 v[128:143], a[88:91], v[112:115], v[128:143]
    v_add_f32 v83, v83, v83
    v_mul_f32 v45, v84, v83
    v_mul_f32 v46, v85, v83
    s_add_u32 m0, s99, 0
    s_nop 0
    buffer_load_dwordx4 v20, s[44:47], s76 offen lds
    s_add_u32 m0, s99, 4096
    s_nop 0
    buffer_load_dwordx4 v20, s[44:47], s77 offen lds
    s_waitcnt lgkmcnt(9)
    v_mfma_f32_32x32x16_bf16 v[144:159], a[88:91], v[116:119], v[144:159]
    ds_read_b128 v[104:107], v17 offset:45056
    ds_read_b128 v[108:111], v93 offset:4096
    v_mfma_f32_32x32x16_bf16 v[160:175], a[168:171], a[88:91], v[160:175]
    s_waitcnt lgkmcnt(5)
    v_mfma_f32_32x32x16_bf16 v[128:143], a[92:95], v[120:123], v[128:143]
    s_add_u32 m0, s99, 77824
    s_nop 0
    buffer_load_dwordx4 v3, s[48:51], s85 offen lds
    s_add_u32 m0, s99, 8192
    s_nop 0
    buffer_load_dwordx4 v20, s[44:47], s78 offen lds
    s_waitcnt lgkmcnt(4)
    v_mfma_f32_32x32x16_bf16 v[144:159], a[92:95], v[124:127], v[144:159]
    ds_read_b128 v[112:115], v18 offset:45056
    ds_read_b128 v[116:119], v94 offset:4096
    v_mfma_f32_32x32x16_bf16 v[160:175], a[172:175], a[92:95], v[160:175]
    s_waitcnt lgkmcnt(5)
    v_mfma_f32_32x32x16_bf16 v[128:143], a[96:99], v[96:99], v[128:143]
    s_waitcnt vmcnt(17)
    ds_read_b128 a[112:115], v52 offset:12288
    ds_read_b128 a[116:119], v53 offset:12288
    ds_read_b128 a[120:123], v54 offset:12288
    ds_read_b128 a[124:127], v55 offset:12288
    s_add_u32 m0, s99, 12288
    s_nop 0
    buffer_load_dwordx4 v20, s[44:47], s79 offen lds
    s_waitcnt lgkmcnt(8)
    v_mfma_f32_32x32x16_bf16 v[144:159], a[96:99], v[100:103], v[144:159]
    ds_read_b128 v[120:123], v19 offset:45056
    ds_read_b128 v[124:127], v95 offset:4096
    v_mfma_f32_32x32x16_bf16 v[160:175], a[176:179], a[96:99], v[160:175]
    s_waitcnt lgkmcnt(9)
    v_mfma_f32_32x32x16_bf16 v[128:143], a[100:103], v[104:107], v[128:143]
    s_waitcnt vmcnt(12)
    ds_read_b128 a[128:131], v52 offset:0
    ds_read_b128 a[132:135], v53 offset:0
    ds_read_b128 a[136:139], v54 offset:0
    ds_read_b128 a[140:143], v55 offset:0
    s_add_u32 m0, s99, 16384
    s_nop 0
    buffer_load_dwordx4 v20, s[44:47], s80 offen lds
    s_waitcnt lgkmcnt(12)
    v_mfma_f32_32x32x16_bf16 v[144:159], a[100:103], v[108:111], v[144:159]
    s_barrier
    ds_read_b128 v[96:99], v16 offset:49152
    ds_read_b128 v[100:103], v92 offset:8192
    v_mfma_f32_32x32x16_bf16 v[160:175], a[180:183], a[100:103], v[160:175]
    s_waitcnt lgkmcnt(13)
    v_mfma_f32_32x32x16_bf16 v[128:143], a[104:107], v[112:115], v[128:143]
    s_add_u32 m0, s99, 20480
    s_nop 0
    buffer_load_dwordx4 v20, s[48:51], s76 offen lds
    s_add_u32 m0, s99, 24576
    s_nop 0
    buffer_load_dwordx4 v20, s[48:51], s77 offen lds
    s_waitcnt lgkmcnt(12)
    v_mfma_f32_32x32x16_bf16 v[144:159], a[104:107], v[116:119], v[144:159]
    ds_read_b128 v[104:107], v17 offset:49152
    ds_read_b128 v[108:111], v93 offset:8192
    v_mfma_f32_32x32x16_bf16 v[160:175], a[184:187], a[104:107], v[160:175]
    s_waitcnt lgkmcnt(9)
    v_mfma_f32_32x32x16_bf16 v[128:143], a[108:111], v[120:123], v[128:143]
    s_waitcnt vmcnt(9)
    ds_read_b128 a[144:147], v52 offset:4096
    ds_read_b128 a[148:151], v53 offset:4096
    ds_read_b128 a[152:155], v54 offset:4096
    ds_read_b128 a[156:159], v55 offset:4096
    s_add_u32 m0, s99, 28672
    s_nop 0
    buffer_load_dwordx4 v20, s[48:51], s78 offen lds
    s_waitcnt lgkmcnt(12)
    v_mfma_f32_32x32x16_bf16 v[144:159], a[108:111], v[124:127], v[144:159]
    ds_read_b128 v[112:115], v18 offset:49152
    ds_read_b128 v[116:119], v94 offset:8192
    v_mfma_f32_32x32x16_bf16 v[160:175], a[188:191], a[108:111], v[160:175]
    s_waitcnt lgkmcnt(9)
    v_mfma_f32_32x32x16_bf16 v[128:143], a[112:115], v[96:99], v[128:143]
    s_add_u32 m0, s99, 32768
    s_nop 0
    buffer_load_dwordx4 v20, s[48:51], s79 offen lds
    s_add_u32 m0, s99, 36864
    s_nop 0
    buffer_load_dwordx4 v20, s[48:51], s80 offen lds
    s_waitcnt lgkmcnt(8)
    v_mfma_f32_32x32x16_bf16 v[144:159], a[112:115], v[100:103], v[144:159]
    ds_read_b128 v[120:123], v19 offset:49152
    ds_read_b128 v[124:127], v95 offset:8192
    v_mfma_f32_32x32x16_bf16 v[160:175], a[192:195], a[112:115], v[160:175]
    s_waitcnt lgkmcnt(9)
    v_mfma_f32_32x32x16_bf16 v[128:143], a[116:119], v[104:107], v[128:143]
    buffer_store_dwordx4 v[64:67], v1, s[40:43], s26 offen sc1
    buffer_store_dwordx4 v[68:71], v1, s[40:43], s26 offen offset:1024 sc1
    buffer_store_dwordx4 v[72:75], v2, s[40:43], s25 offen sc1
    s_add_u32 s96, s25, 5120
    buffer_store_dwordx4 v[76:79], v2, s[40:43], s96 offen sc1
    s_waitcnt lgkmcnt(8)
    v_mfma_f32_32x32x16_bf16 v[144:159], a[116:119], v[108:111], v[144:159]
    s_waitcnt lgkmcnt(4)
    s_barrier
    ds_read_b128 v[96:99], v16 offset:53248
    ds_read_b128 v[100:103], v92 offset:12288
    v_mfma_f32_32x32x16_bf16 v[160:175], a[196:199], a[116:119], v[160:175]
    s_waitcnt lgkmcnt(5)
    v_mfma_f32_32x32x16_bf16 v[128:143], a[120:123], v[112:115], v[128:143]
    s_add_u32 m0, s99, 81920
    s_nop 0
    buffer_load_dwordx4 v20, s[44:47], s81 offen lds
    s_waitcnt lgkmcnt(4)
    v_mfma_f32_32x32x16_bf16 v[144:159], a[120:123], v[116:119], v[144:159]
    ds_read_b128 v[104:107], v17 offset:53248
    ds_read_b128 v[108:111], v93 offset:12288
    v_mfma_f32_32x32x16_bf16 v[160:175], a[200:203], a[120:123], v[160:175]
    s_waitcnt lgkmcnt(5)
    v_mfma_f32_32x32x16_bf16 v[128:143], a[124:127], v[120:123], v[128:143]
    s_add_u32 m0, s99, 86016
    s_nop 0
    buffer_load_dwordx4 v20, s[44:47], s82 offen lds
    s_waitcnt lgkmcnt(4)
    v_mfma_f32_32x32x16_bf16 v[144:159], a[124:127], v[124:127], v[144:159]
    ds_read_b128 v[112:115], v18 offset:53248
    ds_read_b128 v[116:119], v94 offset:12288
    v_mfma_f32_32x32x16_bf16 v[160:175], a[204:207], a[124:127], v[160:175]
    s_waitcnt lgkmcnt(5)
    v_mfma_f32_32x32x16_bf16 v[128:143], a[128:131], v[96:99], v[128:143]
    s_add_u32 m0, s99, 90112
    s_nop 0
    buffer_load_dwordx4 v20, s[44:47], s83 offen lds
    s_waitcnt lgkmcnt(4)
    v_mfma_f32_32x32x16_bf16 v[144:159], a[128:131], v[100:103], v[144:159]
    ds_read_b128 v[120:123], v19 offset:53248
    ds_read_b128 v[124:127], v95 offset:12288
    v_mfma_f32_32x32x16_bf16 v[160:175], a[208:211], a[128:131], v[160:175]
    s_waitcnt lgkmcnt(5)
    v_mfma_f32_32x32x16_bf16 v[128:143], a[132:135], v[104:107], v[128:143]
    s_add_u32 m0, s99, 94208
    s_nop 0
    buffer_load_dwordx4 v20, s[44:47], s84 offen lds
    s_waitcnt lgkmcnt(4)
    v_mfma_f32_32x32x16_bf16 v[144:159], a[132:135], v[108:111], v[144:159]
    s_waitcnt vmcnt(16)
    s_barrier
    ds_read_b128 v[96:99], v16 offset:57344
    ds_read_b128 v[100:103], v92 offset:16384
    v_mfma_f32_32x32x16_bf16 v[160:175], a[212:215], a[132:135], v[160:175]
    s_waitcnt lgkmcnt(5)
    v_mfma_f32_32x32x16_bf16 v[128:143], a[136:139], v[112:115], v[128:143]
    s_add_u32 m0, s99, 98304
    s_nop 0
    buffer_load_dwordx4 v20, s[44:47], s85 offen lds
    s_waitcnt lgkmcnt(4)
    v_mfma_f32_32x32x16_bf16 v[144:159], a[136:139], v[116:119], v[144:159]
    ds_read_b128 v[104:107], v17 offset:57344
    ds_read_b128 v[108:111], v93 offset:16384
    v_mfma_f32_32x32x16_bf16 v[160:175], a[216:219], a[136:139], v[160:175]
    s_waitcnt lgkmcnt(5)
    v_mfma_f32_32x32x16_bf16 v[128:143], a[140:143], v[120:123], v[128:143]
    s_add_u32 m0, s99, 102400
    s_nop 0
    buffer_load_dwordx4 v20, s[48:51], s81 offen lds
    s_waitcnt lgkmcnt(4)
    v_mfma_f32_32x32x16_bf16 v[144:159], a[140:143], v[124:127], v[144:159]
    ds_read_b128 v[112:115], v18 offset:57344
    ds_read_b128 v[116:119], v94 offset:16384
    v_mfma_f32_32x32x16_bf16 v[160:175], a[220:223], a[140:143], v[160:175]
    s_waitcnt lgkmcnt(5)
    v_mfma_f32_32x32x16_bf16 v[128:143], a[144:147], v[96:99], v[128:143]
    s_add_u32 m0, s99, 106496
    s_nop 0
    buffer_load_dwordx4 v20, s[48:51], s82 offen lds
    s_waitcnt lgkmcnt(4)
    v_mfma_f32_32x32x16_bf16 v[144:159], a[144:147], v[100:103], v[144:159]
    ds_read_b128 v[120:123], v19 offset:57344
    ds_read_b128 v[124:127], v95 offset:16384
    v_mfma_f32_32x32x16_bf16 v[160:175], a[224:227], a[144:147], v[160:175]
    s_waitcnt lgkmcnt(5)
    v_mfma_f32_32x32x16_bf16 v[128:143], a[148:151], v[104:107], v[128:143]
    s_add_u32 m0, s99, 110592
    s_nop 0
    buffer_load_dwordx4 v20, s[48:51], s83 offen lds
    s_waitcnt lgkmcnt(4)
    v_mfma_f32_32x32x16_bf16 v[144:159], a[148:151], v[108:111], v[144:159]
    v_mfma_f32_32x32x16_bf16 v[160:175], a[228:231], a[148:151], v[160:175]
    s_waitcnt lgkmcnt(3)
    v_mfma_f32_32x32x16_bf16 v[128:143], a[152:155], v[112:115], v[128:143]
    s_add_u32 m0, s99, 114688
    s_nop 0
    buffer_load_dwordx4 v20, s[48:51], s84 offen lds
    s_waitcnt lgkmcnt(2)
    v_mfma_f32_32x32x16_bf16 v[144:159], a[152:155], v[116:119], v[144:159]
    v_mfma_f32_32x32x16_bf16 v[160:175], a[232:235], a[152:155], v[160:175]
    s_waitcnt lgkmcnt(1)
    v_mfma_f32_32x32x16_bf16 v[128:143], a[156:159], v[120:123], v[128:143]
    s_add_u32 m0, s99, 118784
    s_nop 0
    buffer_load_dwordx4 v20, s[48:51], s85 offen lds
    s_waitcnt lgkmcnt(0)
    v_mfma_f32_32x32x16_bf16 v[144:159], a[156:159], v[124:127], v[144:159]
    v_mfma_f32_32x32x16_bf16 v[160:175], a[236:239], a[156:159], v[160:175]
    v_lshrrev_b32 v84, 5, v0
    s_lshl_b32 s95, s66, 1
    v_add_u32 v84, s95, v84
    v_cmp_eq_u32 s[76:77], 1, v84
    v_cmp_eq_u32 s[78:79], 2, v84
    v_cmp_eq_u32 s[80:81], 3, v84
    v_cmp_eq_u32 s[82:83], 4, v84
    v_cmp_eq_u32 s[84:85], 5, v84
    v_cmp_eq_u32 s[86:87], 6, v84
    v_cmp_eq_u32 s[88:89], 7, v84
    s_nop 1
    v_cvt_pk_bf16_f32 v72, v160, v160
    v_lshlrev_b32 v72, 16, v72
    v_mul_f32 v72, 0xbfb8aa3b, v72
    v_fma_f32 v48, v21, v128, v129
    v_fma_f32 v49, v21, v144, v145
    v_fmac_f32 v48, v23, v144
    v_fmac_f32 v49, v22, v128
    v_fma_f32 v50, v21, v48, v130
    v_fma_f32 v51, v21, v49, v146
    v_fmac_f32 v50, v23, v49
    v_fmac_f32 v51, v22, v48
    v_fma_f32 v48, v21, v50, v131
    v_fma_f32 v49, v21, v51, v147
    v_fmac_f32 v48, v23, v51
    v_fmac_f32 v49, v22, v50
    v_fma_f32 v50, v21, v48, v132
    v_fma_f32 v51, v21, v49, v148
    v_fmac_f32 v50, v23, v49
    v_fmac_f32 v51, v22, v48
    v_fma_f32 v48, v21, v50, v133
    v_fma_f32 v49, v21, v51, v149
    v_fmac_f32 v48, v23, v51
    v_fmac_f32 v49, v22, v50
    v_fma_f32 v50, v21, v48, v134
    v_fma_f32 v51, v21, v49, v150
    v_fmac_f32 v50, v23, v49
    v_fmac_f32 v51, v22, v48
    v_fma_f32 v48, v21, v50, v135
    v_fma_f32 v49, v21, v51, v151
    v_fmac_f32 v48, v23, v51
    v_fmac_f32 v49, v22, v50
    v_fma_f32 v50, v21, v48, v136
    v_fma_f32 v51, v21, v49, v152
    v_fmac_f32 v50, v23, v49
    v_fmac_f32 v51, v22, v48
    v_fma_f32 v48, v21, v50, v137
    v_fma_f32 v49, v21, v51, v153
    v_fmac_f32 v48, v23, v51
    v_fmac_f32 v49, v22, v50
    v_fma_f32 v50, v21, v48, v138
    v_fma_f32 v51, v21, v49, v154
    v_fmac_f32 v50, v23, v49
    v_fmac_f32 v51, v22, v48
    v_fma_f32 v48, v21, v50, v139
    v_fma_f32 v49, v21, v51, v155
    v_fmac_f32 v48, v23, v51
    v_fmac_f32 v49, v22, v50
    v_fma_f32 v50, v21, v48, v140
    v_fma_f32 v51, v21, v49, v156
    v_fmac_f32 v50, v23, v49
    v_fmac_f32 v51, v22, v48
    v_fma_f32 v48, v21, v50, v141
    v_fma_f32 v49, v21, v51, v157
    v_fmac_f32 v48, v23, v51
    v_fmac_f32 v49, v22, v50
    v_fma_f32 v50, v21, v48, v142
    v_fma_f32 v51, v21, v49, v158
    v_fmac_f32 v50, v23, v49
    v_fmac_f32 v51, v22, v48
    v_fma_f32 v48, v21, v50, v143
    v_fma_f32 v49, v21, v51, v159
    v_fmac_f32 v48, v23, v51
    v_fmac_f32 v49, v22, v50
    ds_write_b64 v9, v[48:49] offset:14848
    s_waitcnt vmcnt(19)
    s_waitcnt vmcnt(14)
    s_waitcnt lgkmcnt(0)
    s_barrier
    ds_read_b128 v[96:99], v16 offset:0
    ds_read_b128 v[100:103], v16 offset:20480
    ds_read_b128 v[104:107], v17 offset:0
    ds_read_b128 v[108:111], v17 offset:20480
    ds_read_b128 v[112:115], v18 offset:0
    ds_read_b128 v[116:119], v18 offset:20480
    s_waitcnt lgkmcnt(5)
    v_mfma_f32_32x32x16_bf16 v[160:175], a[0:3], v[96:99], 0
    ds_read_b128 v[56:59], v10 offset:14848
    ds_read_b128 v[60:63], v10 offset:14864
    ds_read_b128 v[64:67], v10 offset:14880
    v_exp_f32 v72, v72
    s_waitcnt lgkmcnt(7)
    v_mfma_f32_32x32x16_bf16 v[176:191], a[0:3], v[100:103], 0
    ds_read_b128 v[68:71], v10 offset:14896
    v_mov_b32 v48, 0
    v_mov_b32 v49, 0
    v_and_b32 v73, 31, v0
    ds_read_b128 v[120:123], v19 offset:0
    ds_read_b128 v[124:127], v19 offset:20480
    s_waitcnt lgkmcnt(9)
    v_mfma_f32_32x32x16_bf16 v[160:175], a[4:7], v[104:107], v[160:175]
    s_waitcnt vmcnt(10)
    v_mov_b32 v76, s64
    v_mov_b32 v77, s65
    v_mov_b32 v78, 0
    s_lshl_b32 s90, s98, 3
    s_add_u32 s90, s90, 0x4000
    buffer_store_dwordx2 v[76:77], v78, s[40:43], s90 offen sc1
    s_waitcnt lgkmcnt(8)
    v_mfma_f32_32x32x16_bf16 v[176:191], a[4:7], v[108:111], v[176:191]
    s_waitcnt lgkmcnt(5)
    v_fmac_f32 v58, v24, v56
    v_fmac_f32 v59, v24, v57
    v_fma_f32 v58, -v25, v57, v58
    v_add_f32 v72, 1.0, v72
    ds_read_b128 v[96:99], v16 offset:4096
    ds_read_b128 v[100:103], v16 offset:24576
    v_mfma_f32_32x32x16_bf16 v[160:175], a[8:11], v[112:115], v[160:175]
    v_fmac_f32 v59, v25, v56
    s_waitcnt lgkmcnt(6)
    v_fmac_f32 v60, v24, v58
    v_fmac_f32 v61, v24, v59
    v_rcp_f32 v72, v72
    v_mfma_f32_32x32x16_bf16 v[176:191], a[8:11], v[116:119], v[176:191]
    v_fma_f32 v60, -v25, v59, v60
    v_fmac_f32 v61, v25, v58
    v_fmac_f32 v62, v24, v60
    v_bfe_u32 v74, v73, 2, 1
    ds_read_b128 v[104:107], v17 offset:4096
    ds_read_b128 v[108:111], v17 offset:24576
    s_waitcnt lgkmcnt(5)
    v_mfma_f32_32x32x16_bf16 v[160:175], a[12:15], v[120:123], v[160:175]
    v_fmac_f32 v63, v24, v61
    v_fma_f32 v62, -v25, v61, v62
    v_fmac_f32 v63, v25, v60
    v_cvt_pk_bf16_f32 v72, v72, v72
    s_waitcnt lgkmcnt(4)
    v_mfma_f32_32x32x16_bf16 v[176:191], a[12:15], v[124:127], v[176:191]
    v_fmac_f32 v64, v24, v62
    v_fmac_f32 v65, v24, v63
    v_fma_f32 v64, -v25, v63, v64
    v_lshlrev_b32 v12, 16, v72
    ds_read_b128 v[112:115], v18 offset:4096
    ds_read_b128 v[116:119], v18 offset:24576
    s_waitcnt lgkmcnt(5)
    v_mfma_f32_32x32x16_bf16 v[160:175], a[16:19], v[96:99], v[160:175]
    v_fmac_f32 v65, v25, v62
    v_fmac_f32 v66, v24, v64
    v_fmac_f32 v67, v24, v65
    v_sub_f32 v72, 1.0, v12
    s_waitcnt lgkmcnt(4)
    v_mfma_f32_32x32x16_bf16 v[176:191], a[16:19], v[100:103], v[176:191]
    v_fma_f32 v66, -v25, v65, v66
    v_fmac_f32 v67, v25, v64
    v_fmac_f32 v68, v24, v66
    v_cvt_pk_bf16_f32 v72, v72, v72
    ds_read_b128 v[120:123], v19 offset:4096
    ds_read_b128 v[124:127], v19 offset:24576
    s_waitcnt lgkmcnt(5)
    v_mfma_f32_32x32x16_bf16 v[160:175], a[20:23], v[104:107], v[160:175]
    v_fmac_f32 v69, v24, v67
    v_fma_f32 v68, -v25, v67, v68
    v_fmac_f32 v69, v25, v66
    v_lshlrev_b32 v13, 16, v72
    s_waitcnt lgkmcnt(4)
    v_mfma_f32_32x32x16_bf16 v[176:191], a[20:23], v[108:111], v[176:191]
    v_fmac_f32 v70, v24, v68
    v_fmac_f32 v71, v24, v69
    v_fma_f32 v70, -v25, v69, v70
    v_lshlrev_b32 v74, 4, v74
    ds_read_b128 v[96:99], v16 offset:8192
    ds_read_b128 v[100:103], v16 offset:28672
    s_waitcnt lgkmcnt(5)
    v_mfma_f32_32x32x16_bf16 v[160:175], a[24:27], v[112:115], v[160:175]
    v_fmac_f32 v71, v25, v68
    v_mov_b32 v88, v70
    v_mov_b32 v89, s64
    v_and_b32 v72, 3, v73
    s_waitcnt lgkmcnt(4)
    v_mfma_f32_32x32x16_bf16 v[176:191], a[24:27], v[116:119], v[176:191]
    v_mov_b32 v90, v71
    v_mov_b32 v91, s64
    s_add_u32 s97, s68, 0
    v_add_u32 v72, v72, v74
    v_lshrrev_b32 v74, 3, v73
    ds_read_b128 v[104:107], v17 offset:8192
    ds_read_b128 v[108:111], v17 offset:28672
    s_waitcnt lgkmcnt(5)
    v_mfma_f32_32x32x16_bf16 v[160:175], a[28:31], v[120:123], v[160:175]
    s_lshl_b32 s97, s97, 4
    s_add_u32 s97, s97, s67
    s_lshl_b32 s97, s97, 9
    v_lshl_add_u32 v72, v74, 2, v72
    s_lshl_b32 s95, s66, 5
    v_add_u32 v72, s95, v72
    v_add_u32 v15, 4096, v14
    s_mul_i32 s24, s71, 450560
    s_add_u32 s24, s24, 0x40000
    s_waitcnt lgkmcnt(4)
    v_mfma_f32_32x32x16_bf16 v[176:191], a[28:31], v[124:127], v[176:191]
    s_add_u32 s97, s97, 0x10000
    buffer_store_dwordx4 v[88:91], v6, s[40:43], s97 offen sc1
    v_cndmask_b32 v48, v48, v56, s[76:77]
    v_lshlrev_b32 v72, 2, v72
    s_mul_i32 s25, s70, 360448
    s_add_u32 s25, s25, 0x400000
    s_mul_i32 s34, s66, 10
    ds_read_b128 v[112:115], v18 offset:8192
    ds_read_b128 v[116:119], v18 offset:28672
    s_waitcnt lgkmcnt(5)
    v_mfma_f32_32x32x16_bf16 v[160:175], a[32:35], v[96:99], v[160:175]
    v_cndmask_b32 v49, v49, v57, s[76:77]
    v_cndmask_b32 v48, v48, v58, s[78:79]
    v_cndmask_b32 v49, v49, v59, s[78:79]
    s_add_u32 s34, s34, 48
    s_mul_i32 s35, s66, 12
    s_sub_u32 s35, s35, 10
    s_waitcnt lgkmcnt(4)
    v_mfma_f32_32x32x16_bf16 v[176:191], a[32:35], v[100:103], v[176:191]
    v_cndmask_b32 v48, v48, v60, s[80:81]
    v_cndmask_b32 v49, v49, v61, s[80:81]
    v_cndmask_b32 v48, v48, v62, s[82:83]
    s_mov_b32 s96, 0
    ds_read_b128 v[120:123], v19 offset:8192
    ds_read_b128 v[124:127], v19 offset:28672
    s_waitcnt lgkmcnt(5)
    v_mfma_f32_32x32x16_bf16 v[160:175], a[36:39], v[104:107], v[160:175]
    v_cndmask_b32 v49, v49, v63, s[82:83]
    v_cndmask_b32 v48, v48, v64, s[84:85]
    v_cndmask_b32 v49, v49, v65, s[84:85]
    v_add_u32 v72, 149504, v72
    s_waitcnt lgkmcnt(4)
    v_mfma_f32_32x32x16_bf16 v[176:191], a[36:39], v[108:111], v[176:191]
    v_cndmask_b32 v48, v48, v66, s[86:87]
    v_cndmask_b32 v49, v49, v67, s[86:87]
    v_cndmask_b32 v48, v48, v68, s[88:89]
    ds_write_b32 v72, v12
    ds_read_b128 v[96:99], v16 offset:12288
    ds_read_b128 v[100:103], v16 offset:32768
    s_waitcnt lgkmcnt(6)
    v_mfma_f32_32x32x16_bf16 v[160:175], a[40:43], v[112:115], v[160:175]
    v_cndmask_b32 v49, v49, v69, s[88:89]
    s_cmp_ge_u32 s96, 22
    s_cselect_b32 s95, 22, 0
    s_sub_u32 s96, s96, s95
    s_cmp_ge_u32 s96, 22
    s_cselect_b32 s95, 22, 0
    s_sub_u32 s96, s96, s95
    s_cmp_lt_u32 s96, 10
    s_cselect_b32 s95, s34, s35
    s_add_u32 s4, s95, s96
    s_waitcnt lgkmcnt(5)
    v_mfma_f32_32x32x16_bf16 v[176:191], a[40:43], v[116:119], v[176:191]
    s_add_u32 s96, s96, 1
    s_cmp_eq_u32 s96, 22
    s_cselect_b32 s96, 0, s96
    s_cmp_lt_u32 s96, 10
    s_cselect_b32 s95, s34, s35
    s_add_u32 s5, s95, s96
    ds_read_b128 v[104:107], v17 offset:12288
    ds_read_b128 v[108:111], v17 offset:32768
    s_waitcnt lgkmcnt(6)
    v_mfma_f32_32x32x16_bf16 v[160:175], a[44:47], v[120:123], v[160:175]
    s_mul_i32 s90, s71, 120
    s_mul_i32 s91, s66, 30
    s_add_u32 s90, s90, s91
    s_add_u32 s96, s96, 1
    s_cmp_eq_u32 s96, 22
    s_cselect_b32 s96, 0, s96
    s_cmp_lt_u32 s96, 10
    s_cselect_b32 s95, s34, s35
    s_add_u32 s6, s95, s96
    s_waitcnt lgkmcnt(5)
    v_mfma_f32_32x32x16_bf16 v[176:191], a[44:47], v[124:127], v[176:191]
    v_and_b32 v83, 31, v0
    v_min_u32 v82, 29, v83
    v_add_u32 v82, s90, v82
    s_add_u32 s96, s96, 1
    s_cmp_eq_u32 s96, 22
    s_cselect_b32 s96, 0, s96
    s_cmp_lt_u32 s96, 10
    s_cselect_b32 s95, s34, s35
    s_add_u32 s7, s95, s96
    ds_read_b128 v[112:115], v18 offset:12288
    ds_read_b128 v[116:119], v18 offset:32768
    s_waitcnt lgkmcnt(5)
    v_mfma_f32_32x32x16_bf16 v[160:175], a[48:51], v[96:99], v[160:175]
    s_lshr_b32 s90, s66, 1
    s_mul_i32 s90, s90, 400
    s_mul_i32 s91, s71, 50
    s_add_u32 s96, s96, 1
    s_cmp_eq_u32 s96, 22
    s_cselect_b32 s96, 0, s96
    s_cmp_lt_u32 s96, 10
    s_cselect_b32 s95, s34, s35
    s_add_u32 s8, s95, s96
    s_waitcnt lgkmcnt(4)
    v_mfma_f32_32x32x16_bf16 v[176:191], a[48:51], v[100:103], v[176:191]
    s_add_u32 s90, s90, s91
    s_and_b32 s91, s66, 1
    s_mul_i32 s91, s91, 25
    s_add_u32 s96, s96, 1
    s_cmp_eq_u32 s96, 22
    s_cselect_b32 s96, 0, s96
    s_cmp_lt_u32 s96, 10
    s_cselect_b32 s95, s34, s35
    s_add_u32 s9, s95, s96
    ds_read_b128 v[120:123], v19 offset:12288
    ds_read_b128 v[124:127], v19 offset:32768
    s_waitcnt lgkmcnt(5)
    v_mfma_f32_32x32x16_bf16 v[160:175], a[52:55], v[104:107], v[160:175]
    s_add_u32 s90, s90, s91
    v_min_u32 v83, 24, v83
    v_add_u32 v83, s90, v83
    s_add_u32 s96, s96, 1
    s_cmp_eq_u32 s96, 22
    s_cselect_b32 s96, 0, s96
    s_cmp_lt_u32 s96, 10
    s_cselect_b32 s95, s34, s35
    s_add_u32 s10, s95, s96
    s_waitcnt lgkmcnt(4)
    v_mfma_f32_32x32x16_bf16 v[176:191], a[52:55], v[108:111], v[176:191]
    v_cmp_gt_u32 vcc, 32, v0
    s_nop 1
    v_cndmask_b32 v82, v83, v82, vcc
    v_lshlrev_b32 v82, 3, v82
    v_add_u32 v82, 0x4000, v82
    s_add_u32 s96, s96, 1
    s_cmp_eq_u32 s96, 22
    s_cselect_b32 s96, 0, s96
    ds_read_b128 v[96:99], v16 offset:16384
    ds_read_b128 v[100:103], v16 offset:36864
    s_waitcnt lgkmcnt(5)
    v_mfma_f32_32x32x16_bf16 v[160:175], a[56:59], v[112:115], v[160:175]
    buffer_load_dwordx2 v[80:81], v82, s[40:43], 0 offen sc1
    s_cmp_lt_u32 s96, 10
    s_cselect_b32 s95, s34, s35
    s_add_u32 s11, s95, s96
    s_add_u32 s96, s96, 1
    s_cmp_eq_u32 s96, 22
    s_cselect_b32 s96, 0, s96
    s_waitcnt lgkmcnt(4)
    v_mfma_f32_32x32x16_bf16 v[176:191], a[56:59], v[116:119], v[176:191]
    s_cmp_lt_u32 s96, 10
    s_cselect_b32 s95, s34, s35
    s_add_u32 s12, s95, s96
    s_add_u32 s96, s96, 1
    s_cmp_eq_u32 s96, 22
    s_cselect_b32 s96, 0, s96
    ds_read_b128 v[104:107], v17 offset:16384
    ds_read_b128 v[108:111], v17 offset:36864
    s_waitcnt lgkmcnt(5)
    v_mfma_f32_32x32x16_bf16 v[160:175], a[60:63], v[120:123], v[160:175]
    s_cmp_lt_u32 s96, 10
    s_cselect_b32 s95, s34, s35
    s_add_u32 s13, s95, s96
    s_add_u32 s96, s96, 1
    s_cmp_eq_u32 s96, 22
    s_cselect_b32 s96, 0, s96
    s_waitcnt lgkmcnt(4)
    v_mfma_f32_32x32x16_bf16 v[176:191], a[60:63], v[124:127], v[176:191]
    s_cmp_lt_u32 s96, 10
    s_cselect_b32 s95, s34, s35
    s_add_u32 s14, s95, s96
    s_add_u32 s96, s96, 1
    s_cmp_eq_u32 s96, 22
    s_cselect_b32 s96, 0, s96
    ds_read_b128 v[112:115], v18 offset:16384
    ds_read_b128 v[116:119], v18 offset:36864
    s_waitcnt lgkmcnt(5)
    v_mfma_f32_32x32x16_bf16 v[160:175], a[64:67], v[96:99], v[160:175]
    s_cmp_lt_u32 s96, 10
    s_cselect_b32 s95, s34, s35
    s_add_u32 s15, s95, s96
    s_add_u32 s96, s96, 1
    s_cmp_eq_u32 s96, 22
    s_cselect_b32 s96, 0, s96
    s_waitcnt lgkmcnt(4)
    v_mfma_f32_32x32x16_bf16 v[176:191], a[64:67], v[100:103], v[176:191]
    s_cmp_lt_u32 s96, 10
    s_cselect_b32 s95, s34, s35
    s_add_u32 s16, s95, s96
    s_add_u32 s96, s96, 1
    s_cmp_eq_u32 s96, 22
    s_cselect_b32 s96, 0, s96
    ds_read_b128 v[120:123], v19 offset:16384
    ds_read_b128 v[124:127], v19 offset:36864
    s_waitcnt lgkmcnt(5)
    v_mfma_f32_32x32x16_bf16 v[160:175], a[68:71], v[104:107], v[160:175]
    s_cmp_lt_u32 s96, 10
    s_cselect_b32 s95, s34, s35
    s_add_u32 s17, s95, s96
    s_add_u32 s96, s96, 1
    s_cmp_eq_u32 s96, 22
    s_cselect_b32 s96, 0, s96
    s_waitcnt lgkmcnt(4)
    v_mfma_f32_32x32x16_bf16 v[176:191], a[68:71], v[108:111], v[176:191]
    s_cmp_lt_u32 s96, 10
    s_cselect_b32 s95, s34, s35
    s_add_u32 s18, s95, s96
    s_add_u32 s96, s96, 1
    s_cmp_eq_u32 s96, 22
    s_cselect_b32 s96, 0, s96
    s_waitcnt vmcnt(3)
    s_barrier
    ds_read_b128 v[96:99], v92 offset:20480
    ds_read_b128 v[100:103], v92 offset:40960
    s_waitcnt lgkmcnt(5)
    v_mfma_f32_32x32x16_bf16 v[160:175], a[72:75], v[112:115], v[160:175]
    s_cmp_lt_u32 s96, 10
    s_cselect_b32 s95, s34, s35
    s_add_u32 s19, s95, s96
    s_add_u32 s96, s96, 1
    s_cmp_eq_u32 s96, 22
    s_cselect_b32 s96, 0, s96
    s_waitcnt lgkmcnt(4)
    v_mfma_f32_32x32x16_bf16 v[176:191], a[72:75], v[116:119], v[176:191]
    s_mov_b32 s29, s96
    ds_read_b128 v[104:107], v93 offset:20480
    ds_read_b128 v[108:111], v93 offset:40960
    s_waitcnt lgkmcnt(5)
    v_mfma_f32_32x32x16_bf16 v[160:175], a[76:79], v[120:123], v[160:175]
    s_waitcnt lgkmcnt(4)
    v_mfma_f32_32x32x16_bf16 v[176:191], a[76:79], v[124:127], v[176:191]
    ds_read_b128 v[112:115], v94 offset:20480
    ds_read_b128 v[116:119], v94 offset:40960
    s_waitcnt lgkmcnt(5)
    v_mfma_f32_32x32x16_bf16 v[160:175], a[80:83], v[96:99], v[160:175]
    s_waitcnt lgkmcnt(4)
    v_mfma_f32_32x32x16_bf16 v[176:191], a[80:83], v[100:103], v[176:191]
    ds_read_b128 v[120:123], v95 offset:20480
    ds_read_b128 v[124:127], v95 offset:40960
    s_waitcnt lgkmcnt(5)
    v_mfma_f32_32x32x16_bf16 v[160:175], a[84:87], v[104:107], v[160:175]
    s_waitcnt lgkmcnt(4)
    v_mfma_f32_32x32x16_bf16 v[176:191], a[84:87], v[108:111], v[176:191]
    s_waitcnt vmcnt(0)
    v_xor_b32 v80, s64, v80
    v_xor_b32 v81, s65, v81
    v_or_b32 v80, v80, v81
    v_cmp_ne_u32 vcc, 0, v80
    s_nop 3
    s_cmp_eq_u64 vcc, 0
    s_nop 1
    s_cbranch_scc1 L_wfB_ok
    s_mov_b32 s91, 0
    s_waitcnt vmcnt(0) lgkmcnt(0)
L_wfB:
    buffer_load_dwordx2 v[80:81], v82, s[40:43], 0 offen sc1
    s_add_u32 s91, s91, 1
    s_waitcnt vmcnt(0)
    v_xor_b32 v80, s64, v80
    v_xor_b32 v81, s65, v81
    v_or_b32 v80, v80, v81
    v_cmp_ne_u32 vcc, 0, v80
    s_nop 3
    s_cmp_eq_u64 vcc, 0
    s_cbranch_scc1 L_wfB_ok
    s_cmp_lt_u32 s91, 0x30d40
    s_cbranch_scc1 L_wfB
L_wfB_ok:
    ds_read_b128 v[96:99], v92 offset:24576
    ds_read_b128 v[100:103], v92 offset:45056
    s_waitcnt lgkmcnt(5)
    v_mfma_f32_32x32x16_bf16 v[160:175], a[88:91], v[112:115], v[160:175]
    s_add_u32 s95, s68, 0
    s_lshl_b32 s95, s95, 13
    s_add_u32 s95, s95, 0x10000
    buffer_load_dwordx4 v[56:59], v7, s[40:43], s95 offen sc1
    buffer_load_dwordx4 v[60:63], v8, s[40:43], s95 offen sc1
    v_mul_f32 v84, v33, v144
    v_mul_f32 v144, v32, v144
    s_waitcnt lgkmcnt(4)
    v_mfma_f32_32x32x16_bf16 v[176:191], a[88:91], v[116:119], v[176:191]
    v_fmac_f32 v144, v33, v128
    v_fma_f32 v128, v32, v128, -v84
    v_mul_f32 v85, v33, v145
    v_and_b32 v86, 31, v0
    ds_read_b128 v[104:107], v93 offset:24576
    ds_read_b128 v[108:111], v93 offset:45056
    s_waitcnt lgkmcnt(5)
    v_mfma_f32_32x32x16_bf16 v[160:175], a[92:95], v[120:123], v[160:175]
    v_mul_f32 v145, v32, v145
    v_fmac_f32 v145, v33, v129
    v_fma_f32 v129, v32, v129, -v85
    s_mul_i32 s26, s4, 5120
    s_add_u32 s26, s26, s24
    buffer_load_dwordx4 a[160:163], v14, s[40:43], s26 offen offset:0 sc1
    s_waitcnt lgkmcnt(4)
    v_mfma_f32_32x32x16_bf16 v[176:191], a[92:95], v[124:127], v[176:191]
    v_mul_f32 v84, v33, v146
    v_mul_f32 v146, v32, v146
    v_fmac_f32 v146, v33, v130
    ds_read_b128 v[112:115], v94 offset:24576
    ds_read_b128 v[116:119], v94 offset:45056
    s_waitcnt lgkmcnt(5)
    v_mfma_f32_32x32x16_bf16 v[160:175], a[96:99], v[96:99], v[160:175]
    v_fma_f32 v130, v32, v130, -v84
    v_mul_f32 v85, v33, v147
    v_mul_f32 v147, v32, v147
    buffer_load_dwordx4 a[164:167], v14, s[40:43], s26 offen offset:1024 sc1
    s_waitcnt lgkmcnt(4)
    v_mfma_f32_32x32x16_bf16 v[176:191], a[96:99], v[100:103], v[176:191]
    v_fmac_f32 v147, v33, v131
    v_fma_f32 v131, v32, v131, -v85
    v_mul_f32 v84, v33, v148
    v_lshrrev_b32 v88, 3, v86
    ds_read_b128 v[120:123], v95 offset:24576
    ds_read_b128 v[124:127], v95 offset:45056
    s_waitcnt lgkmcnt(5)
    v_mfma_f32_32x32x16_bf16 v[160:175], a[100:103], v[104:107], v[160:175]
    v_mul_f32 v148, v32, v148
    v_fmac_f32 v148, v33, v132
    v_fma_f32 v132, v32, v132, -v84
    buffer_load_dwordx4 a[168:171], v14, s[40:43], s26 offen offset:2048 sc1
    s_waitcnt lgkmcnt(4)
    v_mfma_f32_32x32x16_bf16 v[176:191], a[100:103], v[108:111], v[176:191]
    v_mul_f32 v85, v33, v149
    v_mul_f32 v149, v32, v149
    v_fmac_f32 v149, v33, v133
    v_and_b32 v87, 3, v86
    ds_read_b128 v[96:99], v92 offset:28672
    ds_read_b128 v[100:103], v92 offset:49152
    s_waitcnt lgkmcnt(5)
    v_mfma_f32_32x32x16_bf16 v[160:175], a[104:107], v[112:115], v[160:175]
    v_fma_f32 v133, v32, v133, -v85
    v_mul_f32 v84, v33, v150
    v_mul_f32 v150, v32, v150
    buffer_load_dwordx4 a[172:175], v14, s[40:43], s26 offen offset:3072 sc1
    s_waitcnt lgkmcnt(4)
    v_mfma_f32_32x32x16_bf16 v[176:191], a[104:107], v[116:119], v[176:191]
    v_fmac_f32 v150, v33, v134
    v_fma_f32 v134, v32, v134, -v84
    v_mul_f32 v85, v33, v151
    v_lshl_add_u32 v87, v88, 2, v87
    ds_read_b128 v[104:107], v93 offset:28672
    ds_read_b128 v[108:111], v93 offset:49152
    s_waitcnt lgkmcnt(5)
    v_mfma_f32_32x32x16_bf16 v[160:175], a[108:111], v[120:123], v[160:175]
    v_mul_f32 v151, v32, v151
    v_fmac_f32 v151, v33, v135
    v_fma_f32 v135, v32, v135, -v85
    buffer_load_dwordx4 a[176:179], v15, s[40:43], s26 offen sc1
    s_waitcnt lgkmcnt(4)
    v_mfma_f32_32x32x16_bf16 v[176:191], a[108:111], v[124:127], v[176:191]
    v_mul_f32 v84, v33, v152
    v_mul_f32 v152, v32, v152
    v_fmac_f32 v152, v33, v136
    v_bfe_u32 v88, v86, 2, 1
    ds_read_b128 v[112:115], v94 offset:28672
    ds_read_b128 v[116:119], v94 offset:49152
    s_waitcnt lgkmcnt(5)
    v_mfma_f32_32x32x16_bf16 v[160:175], a[112:115], v[96:99], v[160:175]
    v_fma_f32 v136, v32, v136, -v84
    v_mul_f32 v85, v33, v153
    v_mul_f32 v153, v32, v153
    s_mul_i32 s26, s5, 5120
    s_add_u32 s26, s26, s24
    buffer_load_dwordx4 a[180:183], v14, s[40:43], s26 offen offset:0 sc1
    s_waitcnt lgkmcnt(4)
    v_mfma_f32_32x32x16_bf16 v[176:191], a[112:115], v[100:103], v[176:191]
    v_fmac_f32 v153, v33, v137
    v_fma_f32 v137, v32, v137, -v85
    v_mul_f32 v84, v33, v154
    v_lshrrev_b32 v89, 5, v0
    ds_read_b128 v[120:123], v95 offset:28672
    ds_read_b128 v[124:127], v95 offset:49152
    s_waitcnt lgkmcnt(5)
    v_mfma_f32_32x32x16_bf16 v[160:175], a[116:119], v[104:107], v[160:175]
    v_mul_f32 v154, v32, v154
    v_fmac_f32 v154, v33, v138
    v_fma_f32 v138, v32, v138, -v84
    buffer_load_dwordx4 a[184:187], v14, s[40:43], s26 offen offset:1024 sc1
    s_waitcnt lgkmcnt(4)
    v_mfma_f32_32x32x16_bf16 v[176:191], a[116:119], v[108:111], v[176:191]
    v_mul_f32 v85, v33, v155
    v_mul_f32 v155, v32, v155
    v_fmac_f32 v155, v33, v139
    v_cmp_eq_u32 vcc, v88, v89
    s_nop 1
    v_cndmask_b32 v87, 31, v87, vcc
    v_fma_f32 v139, v32, v139, -v85
    v_mul_f32 v84, v33, v156
    v_mul_f32 v156, v32, v156
    v_fmac_f32 v156, v33, v140
    v_fma_f32 v140, v32, v140, -v84
    v_mul_f32 v85, v33, v157
    v_mul_f32 v157, v32, v157
    v_fmac_f32 v157, v33, v141
    v_fma_f32 v141, v32, v141, -v85
    v_mul_f32 v84, v33, v158
    v_mul_f32 v158, v32, v158
    v_fmac_f32 v158, v33, v142
    v_fma_f32 v142, v32, v142, -v84
    v_mul_f32 v85, v33, v159
    v_mul_f32 v159, v32, v159
    v_fmac_f32 v159, v33, v143
    v_fma_f32 v143, v32, v143, -v85
    s_waitcnt vmcnt(8)
    v_xor_b32 v64, s64, v57
    v_xor_b32 v65, s64, v59
    s_waitcnt vmcnt(7)
    v_xor_b32 v66, s64, v61
    v_xor_b32 v67, s64, v63
    v_or3_b32 v64, v64, v65, v66
    v_or_b32 v64, v64, v67
    v_cmp_ne_u32 vcc, 0, v64
    s_nop 3
    s_cmp_eq_u64 vcc, 0
    s_cbranch_scc1 L_lbB0_ok
    s_mov_b32 s91, 0
    s_waitcnt vmcnt(0) lgkmcnt(0)
L_lbB0:
    buffer_load_dwordx4 v[56:59], v7, s[40:43], s95 offen sc1
    buffer_load_dwordx4 v[60:63], v8, s[40:43], s95 offen sc1
    s_add_u32 s91, s91, 1
    s_waitcnt vmcnt(1)
    v_xor_b32 v64, s64, v57
    v_xor_b32 v65, s64, v59
    s_waitcnt vmcnt(0)
    v_xor_b32 v66, s64, v61
    v_xor_b32 v67, s64, v63
    v_or3_b32 v64, v64, v65, v66
    v_or_b32 v64, v64, v67
    v_cmp_ne_u32 vcc, 0, v64
    s_nop 3
    s_cmp_eq_u64 vcc, 0
    s_cbranch_scc1 L_lbB0_ok
    s_cmp_lt_u32 s91, 0x30d40
    s_cbranch_scc1 L_lbB0
L_lbB0_ok:
    v_mul_f32 v64, v28, v56
    v_mul_f32 v65, v28, v58
    v_fma_f32 v64, -v29, v58, v64
    v_fmac_f32 v65, v29, v56
    v_fmac_f32 v64, v30, v60
    v_fmac_f32 v65, v30, v62
    v_fma_f32 v64, -v31, v62, v64
    v_fmac_f32 v65, v31, v60
    ds_write_b64 v9, v[64:65] offset:6656
    s_waitcnt lgkmcnt(0)
    s_barrier
    ds_read_b128 v[96:99], v92 offset:32768
    ds_read_b128 v[100:103], v92 offset:53248
    v_mfma_f32_32x32x16_bf16 v[160:175], a[120:123], v[112:115], v[160:175]
    v_lshrrev_b32 v89, 16, v12
    v_and_b32 v88, 1, v87
    v_lshlrev_b32 v88, 4, v88
    ds_read_b128 v[56:59], v10 offset:6656
    ds_read_b128 v[60:63], v10 offset:6672
    v_mfma_f32_32x32x16_bf16 v[176:191], a[120:123], v[116:119], v[176:191]
    v_lshlrev_b32 v89, v88, v89
    v_lshrrev_b32 v87, 1, v87
    v_cmp_eq_u32 vcc, 0, v87
    s_nop 1
    v_cndmask_b32 v72, 0, v89, vcc
    ds_read_b128 v[64:67], v10 offset:6688
    ds_read_b128 v[104:107], v93 offset:32768
    ds_read_b128 v[108:111], v93 offset:53248
    v_mfma_f32_32x32x16_bf16 v[160:175], a[124:127], v[120:123], v[160:175]
    v_cmp_eq_u32 vcc, 1, v87
    s_nop 1
    v_cndmask_b32 v73, 0, v89, vcc
    v_cmp_eq_u32 vcc, 2, v87
    s_nop 1
    v_cndmask_b32 v74, 0, v89, vcc
    v_cmp_eq_u32 vcc, 3, v87
    s_nop 1
    v_cndmask_b32 v75, 0, v89, vcc
    v_mfma_f32_32x32x16_bf16 v[176:191], a[124:127], v[124:127], v[176:191]
    v_cmp_eq_u32 vcc, 4, v87
    s_nop 1
    v_cndmask_b32 v76, 0, v89, vcc
    v_cmp_eq_u32 vcc, 5, v87
    s_nop 1
    v_cndmask_b32 v77, 0, v89, vcc
    ds_read_b128 v[112:115], v94 offset:32768
    ds_read_b128 v[116:119], v94 offset:53248
    s_waitcnt lgkmcnt(8)
    v_mfma_f32_32x32x16_bf16 v[160:175], a[128:131], v[96:99], v[160:175]
    v_cmp_eq_u32 vcc, 6, v87
    s_nop 1
    v_cndmask_b32 v78, 0, v89, vcc
    v_cmp_eq_u32 vcc, 7, v87
    s_nop 1
    v_cndmask_b32 v79, 0, v89, vcc
    ds_read_b128 v[68:71], v10 offset:6704
    s_waitcnt lgkmcnt(8)
    v_mfma_f32_32x32x16_bf16 v[176:191], a[128:131], v[100:103], v[176:191]
    s_waitcnt lgkmcnt(7)
    v_add_f32 v56, v56, v58
    v_add_f32 v57, v57, v59
    s_waitcnt lgkmcnt(6)
    v_add_f32 v60, v60, v62
    v_add_f32 v61, v61, v63
    ds_read_b128 v[120:123], v95 offset:32768
    ds_read_b128 v[124:127], v95 offset:53248
    s_waitcnt lgkmcnt(6)
    v_mfma_f32_32x32x16_bf16 v[160:175], a[132:135], v[104:107], v[160:175]
    v_add_f32 v64, v64, v66
    v_add_f32 v65, v65, v67
    s_waitcnt lgkmcnt(2)
    v_add_f32 v68, v68, v70
    v_add_f32 v69, v69, v71
    buffer_load_dwordx4 a[188:191], v14, s[40:43], s26 offen offset:2048 sc1
    v_mfma_f32_32x32x16_bf16 v[176:191], a[132:135], v[108:111], v[176:191]
    v_add_f32 v56, v56, v60
    v_add_f32 v57, v57, v61
    v_add_f32 v64, v64, v68
    v_add_f32 v65, v65, v69
    ds_read_b128 v[96:99], v92 offset:36864
    ds_read_b128 v[100:103], v92 offset:57344
    v_mfma_f32_32x32x16_bf16 v[160:175], a[136:139], v[112:115], v[160:175]
    v_add_f32 v56, v56, v64
    v_add_f32 v57, v57, v65
    v_fmac_f32 v48, v26, v56
    v_fmac_f32 v49, v26, v57
    buffer_load_dwordx4 a[192:195], v14, s[40:43], s26 offen offset:3072 sc1
    v_mfma_f32_32x32x16_bf16 v[176:191], a[136:139], v[116:119], v[176:191]
    v_fma_f32 v48, -v27, v57, v48
    v_fmac_f32 v49, v27, v56
    v_mul_f32 v58, v32, v48
    v_mul_f32 v59, v32, v49
    ds_read_b128 v[104:107], v93 offset:36864
    ds_read_b128 v[108:111], v93 offset:57344
    s_waitcnt lgkmcnt(5)
    v_mfma_f32_32x32x16_bf16 v[160:175], a[140:143], v[120:123], v[160:175]
    v_fma_f32 v58, -v33, v49, v58
    v_fmac_f32 v59, v33, v48
    v_fmac_f32 v128, v21, v58
    v_fmac_f32 v144, v21, v59
    buffer_load_dwordx4 a[196:199], v15, s[40:43], s26 offen sc1
    s_waitcnt lgkmcnt(4)
    v_mfma_f32_32x32x16_bf16 v[176:191], a[140:143], v[124:127], v[176:191]
    v_fmac_f32 v128, v23, v59
    v_fmac_f32 v144, v22, v58
    v_fmac_f32 v129, v21, v128
    v_fmac_f32 v145, v21, v144
    ds_read_b128 v[112:115], v94 offset:36864
    ds_read_b128 v[116:119], v94 offset:57344
    s_waitcnt lgkmcnt(5)
    v_mfma_f32_32x32x16_bf16 v[160:175], a[144:147], v[96:99], v[160:175]
    v_fmac_f32 v129, v23, v144
    v_fmac_f32 v145, v22, v128
    v_fmac_f32 v130, v21, v129
    v_fmac_f32 v146, v21, v145
    s_mul_i32 s26, s6, 5120
    s_add_u32 s26, s26, s24
    buffer_load_dwordx4 a[200:203], v14, s[40:43], s26 offen offset:0 sc1
    s_waitcnt lgkmcnt(4)
    v_mfma_f32_32x32x16_bf16 v[176:191], a[144:147], v[100:103], v[176:191]
    v_fmac_f32 v130, v23, v145
    v_fmac_f32 v146, v22, v129
    v_fmac_f32 v131, v21, v130
    v_fmac_f32 v147, v21, v146
    ds_read_b128 v[120:123], v95 offset:36864
    ds_read_b128 v[124:127], v95 offset:57344
    s_waitcnt lgkmcnt(5)
    v_mfma_f32_32x32x16_bf16 v[160:175], a[148:151], v[104:107], v[160:175]
    v_fmac_f32 v131, v23, v146
    v_fmac_f32 v147, v22, v130
    v_fmac_f32 v132, v21, v131
    v_fmac_f32 v148, v21, v147
    buffer_load_dwordx4 a[204:207], v14, s[40:43], s26 offen offset:1024 sc1
    s_waitcnt lgkmcnt(4)
    v_mfma_f32_32x32x16_bf16 v[176:191], a[148:151], v[108:111], v[176:191]
    v_fmac_f32 v132, v23, v147
    v_fmac_f32 v148, v22, v131
    v_fmac_f32 v133, v21, v132
    v_fmac_f32 v149, v21, v148
    s_waitcnt lgkmcnt(3)
    v_mfma_f32_32x32x16_bf16 v[160:175], a[152:155], v[112:115], v[160:175]
    v_fmac_f32 v133, v23, v148
    v_fmac_f32 v149, v22, v132
    v_fmac_f32 v134, v21, v133
    v_fmac_f32 v150, v21, v149
    buffer_load_dwordx4 a[208:211], v14, s[40:43], s26 offen offset:2048 sc1
    s_waitcnt lgkmcnt(2)
    v_mfma_f32_32x32x16_bf16 v[176:191], a[152:155], v[116:119], v[176:191]
    v_fmac_f32 v134, v23, v149
    v_fmac_f32 v150, v22, v133
    v_fmac_f32 v135, v21, v134
    v_fmac_f32 v151, v21, v150
    s_waitcnt lgkmcnt(1)
    v_mfma_f32_32x32x16_bf16 v[160:175], a[156:159], v[120:123], v[160:175]
    v_fmac_f32 v135, v23, v150
    v_fmac_f32 v151, v22, v134
    v_fmac_f32 v136, v21, v135
    v_fmac_f32 v152, v21, v151
    buffer_load_dwordx4 a[212:215], v14, s[40:43], s26 offen offset:3072 sc1
    s_waitcnt lgkmcnt(0)
    v_mfma_f32_32x32x16_bf16 v[176:191], a[156:159], v[124:127], v[176:191]
    v_fmac_f32 v136, v23, v151
    v_fmac_f32 v152, v22, v135
    v_fmac_f32 v137, v21, v136
    v_fmac_f32 v153, v21, v152
    s_nop 0
    v_fma_f32 v52, v34, v160, v161
    s_nop 5
    v_fma_f32 v53, v34, v176, v177
    v_fmac_f32 v52, v36, v176
    v_fmac_f32 v53, v35, v160
    v_fma_f32 v54, v34, v52, v162
    v_fma_f32 v55, v34, v53, v178
    v_fmac_f32 v54, v36, v53
    v_fmac_f32 v55, v35, v52
    v_fma_f32 v52, v34, v54, v163
    v_fma_f32 v53, v34, v55, v179
    v_fmac_f32 v52, v36, v55
    v_fmac_f32 v53, v35, v54
    v_fma_f32 v54, v34, v52, v164
    v_fma_f32 v55, v34, v53, v180
    v_fmac_f32 v54, v36, v53
    v_fmac_f32 v55, v35, v52
    v_fma_f32 v52, v34, v54, v165
    v_fma_f32 v53, v34, v55, v181
    v_fmac_f32 v52, v36, v55
    v_fmac_f32 v53, v35, v54
    v_fma_f32 v54, v34, v52, v166
    v_fma_f32 v55, v34, v53, v182
    v_fmac_f32 v54, v36, v53
    v_fmac_f32 v55, v35, v52
    v_fma_f32 v52, v34, v54, v167
    v_fma_f32 v53, v34, v55, v183
    v_fmac_f32 v52, v36, v55
    v_fmac_f32 v53, v35, v54
    v_fma_f32 v54, v34, v52, v168
    v_fma_f32 v55, v34, v53, v184
    v_fmac_f32 v54, v36, v53
    v_fmac_f32 v55, v35, v52
    v_fma_f32 v52, v34, v54, v169
    v_fma_f32 v53, v34, v55, v185
    v_fmac_f32 v52, v36, v55
    v_fmac_f32 v53, v35, v54
    v_fma_f32 v54, v34, v52, v170
    v_fma_f32 v55, v34, v53, v186
    v_fmac_f32 v54, v36, v53
    v_fmac_f32 v55, v35, v52
    v_fma_f32 v52, v34, v54, v171
    v_fma_f32 v53, v34, v55, v187
    v_fmac_f32 v52, v36, v55
    v_fmac_f32 v53, v35, v54
    v_fma_f32 v54, v34, v52, v172
    v_fma_f32 v55, v34, v53, v188
    v_fmac_f32 v54, v36, v53
    v_fmac_f32 v55, v35, v52
    v_fma_f32 v52, v34, v54, v173
    v_fma_f32 v53, v34, v55, v189
    v_fmac_f32 v52, v36, v55
    v_fmac_f32 v53, v35, v54
    v_fma_f32 v54, v34, v52, v174
    v_fma_f32 v55, v34, v53, v190
    v_fmac_f32 v54, v36, v53
    v_fmac_f32 v55, v35, v52
    v_fma_f32 v52, v34, v54, v175
    v_fma_f32 v53, v34, v55, v191
    v_fmac_f32 v52, v36, v55
    v_fmac_f32 v53, v35, v54
    ds_write_b64 v9, v[52:53] offset:17408
    s_waitcnt lgkmcnt(0)
    s_barrier
    ds_read_b128 v[96:99], v10 offset:17408
    ds_read_b128 v[100:103], v10 offset:17424
    ds_read_b128 v[104:107], v10 offset:17440
    ds_read_b128 v[108:111], v10 offset:17456
    v_mov_b32 v52, 0
    v_mov_b32 v53, 0
    s_waitcnt lgkmcnt(3)
    v_fmac_f32 v98, v37, v96
    v_fmac_f32 v99, v37, v97
    buffer_load_dwordx4 a[216:219], v15, s[40:43], s26 offen sc1
    v_fma_f32 v98, -v38, v97, v98
    v_fmac_f32 v99, v38, v96
    s_waitcnt lgkmcnt(2)
    v_fmac_f32 v100, v37, v98
    v_fmac_f32 v101, v37, v99
    v_fma_f32 v100, -v38, v99, v100
    v_fmac_f32 v101, v38, v98
    v_fmac_f32 v102, v37, v100
    v_fmac_f32 v103, v37, v101
    s_mul_i32 s26, s7, 5120
    s_add_u32 s26, s26, s24
    buffer_load_dwordx4 a[220:223], v14, s[40:43], s26 offen offset:0 sc1
    v_fma_f32 v102, -v38, v101, v102
    v_fmac_f32 v103, v38, v100
    s_waitcnt lgkmcnt(1)
    v_fmac_f32 v104, v37, v102
    v_fmac_f32 v105, v37, v103
    v_fma_f32 v104, -v38, v103, v104
    v_fmac_f32 v105, v38, v102
    v_fmac_f32 v106, v37, v104
    v_fmac_f32 v107, v37, v105
    buffer_load_dwordx4 a[224:227], v14, s[40:43], s26 offen offset:1024 sc1
    v_fma_f32 v106, -v38, v105, v106
    v_fmac_f32 v107, v38, v104
    s_waitcnt lgkmcnt(0)
    v_fmac_f32 v108, v37, v106
    v_fmac_f32 v109, v37, v107
    v_fma_f32 v108, -v38, v107, v108
    v_fmac_f32 v109, v38, v106
    v_fmac_f32 v110, v37, v108
    v_fmac_f32 v111, v37, v109
    buffer_load_dwordx4 a[228:231], v14, s[40:43], s26 offen offset:2048 sc1
    v_fma_f32 v110, -v38, v109, v110
    v_fmac_f32 v111, v38, v108
    v_mov_b32 v88, v110
    v_mov_b32 v89, s64
    v_mov_b32 v90, v111
    v_mov_b32 v91, s64
    s_add_u32 s97, s68, 1
    s_lshl_b32 s97, s97, 4
    buffer_load_dwordx4 a[232:235], v14, s[40:43], s26 offen offset:3072 sc1
    s_add_u32 s97, s97, s67
    s_lshl_b32 s97, s97, 9
    s_add_u32 s97, s97, 0x10000
    buffer_store_dwordx4 v[88:91], v6, s[40:43], s97 offen sc1
    v_cndmask_b32 v52, v52, v96, s[76:77]
    v_cndmask_b32 v53, v53, v97, s[76:77]
    v_cndmask_b32 v52, v52, v98, s[78:79]
    v_cndmask_b32 v53, v53, v99, s[78:79]
    buffer_load_dwordx4 a[236:239], v15, s[40:43], s26 offen sc1
    v_cndmask_b32 v52, v52, v100, s[80:81]
    v_cndmask_b32 v53, v53, v101, s[80:81]
    v_cndmask_b32 v52, v52, v102, s[82:83]
    v_cndmask_b32 v53, v53, v103, s[82:83]
    v_cndmask_b32 v52, v52, v104, s[84:85]
    v_cndmask_b32 v53, v53, v105, s[84:85]
    v_cndmask_b32 v52, v52, v106, s[86:87]
    v_cndmask_b32 v53, v53, v107, s[86:87]
    s_mul_i32 s26, s8, 5120
    s_add_u32 s26, s26, s24
    buffer_load_dwordx4 a[240:243], v14, s[40:43], s26 offen offset:0 sc1
    v_cndmask_b32 v52, v52, v108, s[88:89]
    v_cndmask_b32 v53, v53, v109, s[88:89]
    v_fmac_f32 v137, v23, v152
    v_fmac_f32 v153, v22, v136
    v_fmac_f32 v138, v21, v137
    v_fmac_f32 v154, v21, v153
    v_fmac_f32 v138, v23, v153
    v_fmac_f32 v154, v22, v137
    v_fmac_f32 v139, v21, v138
    v_fmac_f32 v155, v21, v154
    v_fmac_f32 v139, v23, v154
    v_fmac_f32 v155, v22, v138
    v_fmac_f32 v140, v21, v139
    v_fmac_f32 v156, v21, v155
    v_fmac_f32 v140, v23, v155
    v_fmac_f32 v156, v22, v139
    v_fmac_f32 v141, v21, v140
    v_fmac_f32 v157, v21, v156
    v_fmac_f32 v141, v23, v156
    v_fmac_f32 v157, v22, v140
    v_fmac_f32 v142, v21, v141
    v_fmac_f32 v158, v21, v157
    v_fmac_f32 v142, v23, v157
    v_fmac_f32 v158, v22, v141
    v_fmac_f32 v143, v21, v142
    v_fmac_f32 v159, v21, v158
    v_fmac_f32 v143, v23, v158
    v_fmac_f32 v159, v22, v142
    v_cvt_pk_bf16_f32 v128, v128, v129
    v_cvt_pk_bf16_f32 v129, v130, v131
    v_cvt_pk_bf16_f32 v130, v132, v133
    v_cvt_pk_bf16_f32 v131, v134, v135
    v_cvt_pk_bf16_f32 v132, v136, v137
    v_cvt_pk_bf16_f32 v133, v138, v139
    v_cvt_pk_bf16_f32 v134, v140, v141
    v_cvt_pk_bf16_f32 v135, v142, v143
    v_cvt_pk_bf16_f32 v136, -v144, -v145
    v_cvt_pk_bf16_f32 v137, -v146, -v147
    v_cvt_pk_bf16_f32 v138, -v148, -v149
    v_cvt_pk_bf16_f32 v139, -v150, -v151
    v_cvt_pk_bf16_f32 v140, -v152, -v153
    v_cvt_pk_bf16_f32 v141, -v154, -v155
    v_cvt_pk_bf16_f32 v142, -v156, -v157
    v_cvt_pk_bf16_f32 v143, -v158, -v159
    v_mfma_f32_32x32x16_bf16 v[144:159], v[128:131], v[72:75], 0
    v_mfma_f32_32x32x16_bf16 v[96:111], v[136:139], v[72:75], 0
    v_mfma_f32_32x32x16_bf16 v[144:159], v[132:135], v[76:79], v[144:159]
    v_mfma_f32_32x32x16_bf16 v[96:111], v[140:143], v[76:79], v[96:111]
    buffer_load_dwordx4 a[244:247], v14, s[40:43], s26 offen offset:1024 sc1
    s_nop 9
    v_cvt_pk_bf16_f32 v144, v144, v145
    v_cvt_pk_bf16_f32 v145, v146, v147
    v_cvt_pk_bf16_f32 v146, v148, v149
    v_cvt_pk_bf16_f32 v147, v150, v151
    v_cvt_pk_bf16_f32 v148, v152, v153
    buffer_load_dwordx4 a[248:251], v14, s[40:43], s26 offen offset:2048 sc1
    v_cvt_pk_bf16_f32 v149, v154, v155
    v_cvt_pk_bf16_f32 v150, v156, v157
    v_cvt_pk_bf16_f32 v151, v158, v159
    s_add_u32 s97, s23, 196608
    buffer_store_dwordx4 v[144:147], v5, s[40:43], s97 offen sc1
    s_add_u32 s97, s23, 196608
    buffer_store_dwordx4 v[148:151], v5, s[40:43], s97 offen offset:512 sc1
    v_cvt_pk_bf16_f32 v96, v96, v97
    buffer_load_dwordx4 a[252:255], v14, s[40:43], s26 offen offset:3072 sc1
    v_cvt_pk_bf16_f32 v97, v98, v99
    v_cvt_pk_bf16_f32 v98, v100, v101
    v_cvt_pk_bf16_f32 v99, v102, v103
    v_cvt_pk_bf16_f32 v100, v104, v105
    v_cvt_pk_bf16_f32 v101, v106, v107
    v_cvt_pk_bf16_f32 v102, v108, v109
    buffer_load_dwordx4 v[192:195], v15, s[40:43], s26 offen sc1
    v_cvt_pk_bf16_f32 v103, v110, v111
    s_add_u32 s97, s23, 278528
    buffer_store_dwordx4 v[96:99], v5, s[40:43], s97 offen sc1
    s_add_u32 s97, s23, 278528
    buffer_store_dwordx4 v[100:103], v5, s[40:43], s97 offen offset:512 sc1
    v_mul_f32 v84, v46, v176
    v_mul_f32 v176, v45, v176
    v_fmac_f32 v176, v46, v160
    v_fma_f32 v160, v45, v160, -v84
    v_mul_f32 v85, v46, v177
    v_mul_f32 v177, v45, v177
    s_mul_i32 s26, s9, 5120
    s_add_u32 s26, s26, s24
    buffer_load_dwordx4 v[196:199], v14, s[40:43], s26 offen offset:0 sc1
    v_fmac_f32 v177, v46, v161
    v_fma_f32 v161, v45, v161, -v85
    v_mul_f32 v84, v46, v178
    v_mul_f32 v178, v45, v178
    v_fmac_f32 v178, v46, v162
    v_fma_f32 v162, v45, v162, -v84
    buffer_load_dwordx4 v[200:203], v14, s[40:43], s26 offen offset:1024 sc1
    v_mul_f32 v85, v46, v179
    v_mul_f32 v179, v45, v179
    v_fmac_f32 v179, v46, v163
    v_fma_f32 v163, v45, v163, -v85
    v_mul_f32 v84, v46, v180
    v_mul_f32 v180, v45, v180
    buffer_load_dwordx4 v[204:207], v14, s[40:43], s26 offen offset:2048 sc1
    v_fmac_f32 v180, v46, v164
    v_fma_f32 v164, v45, v164, -v84
    v_mul_f32 v85, v46, v181
    v_mul_f32 v181, v45, v181
    v_fmac_f32 v181, v46, v165
    v_fma_f32 v165, v45, v165, -v85
    buffer_load_dwordx4 v[208:211], v14, s[40:43], s26 offen offset:3072 sc1
    v_mul_f32 v84, v46, v182
    v_mul_f32 v182, v45, v182
    v_fmac_f32 v182, v46, v166
    v_fma_f32 v166, v45, v166, -v84
    v_mul_f32 v85, v46, v183
    v_mul_f32 v183, v45, v183
    buffer_load_dwordx4 v[212:215], v15, s[40:43], s26 offen sc1
    v_fmac_f32 v183, v46, v167
    v_fma_f32 v167, v45, v167, -v85
    v_mul_f32 v84, v46, v184
    v_mul_f32 v184, v45, v184
    v_fmac_f32 v184, v46, v168
    v_fma_f32 v168, v45, v168, -v84
    s_mul_i32 s26, s10, 5120
    s_add_u32 s26, s26, s24
    buffer_load_dwordx4 v[216:219], v14, s[40:43], s26 offen offset:0 sc1
    v_mul_f32 v85, v46, v185
    v_mul_f32 v185, v45, v185
    v_fmac_f32 v185, v46, v169
    v_fma_f32 v169, v45, v169, -v85
    v_mul_f32 v84, v46, v186
    v_mul_f32 v186, v45, v186
    buffer_load_dwordx4 v[220:223], v14, s[40:43], s26 offen offset:1024 sc1
    v_fmac_f32 v186, v46, v170
    v_fma_f32 v170, v45, v170, -v84
    v_mul_f32 v85, v46, v187
    v_mul_f32 v187, v45, v187
    v_fmac_f32 v187, v46, v171
    v_fma_f32 v171, v45, v171, -v85
    buffer_load_dwordx4 v[224:227], v14, s[40:43], s26 offen offset:2048 sc1
    v_mul_f32 v84, v46, v188
    v_mul_f32 v188, v45, v188
    v_fmac_f32 v188, v46, v172
    v_fma_f32 v172, v45, v172, -v84
    v_mul_f32 v85, v46, v189
    v_mul_f32 v189, v45, v189
    buffer_load_dwordx4 v[228:231], v14, s[40:43], s26 offen offset:3072 sc1
    v_fmac_f32 v189, v46, v173
    v_fma_f32 v173, v45, v173, -v85
    v_mul_f32 v84, v46, v190
    v_mul_f32 v190, v45, v190
    v_fmac_f32 v190, v46, v174
    v_fma_f32 v174, v45, v174, -v84
    buffer_load_dwordx4 v[232:235], v15, s[40:43], s26 offen sc1
    v_mul_f32 v85, v46, v191
    v_mul_f32 v191, v45, v191
    v_fmac_f32 v191, v46, v175
    v_fma_f32 v175, v45, v175, -v85
    s_add_u32 s95, s68, 1
    s_lshl_b32 s95, s95, 13
    s_add_u32 s95, s95, 0x10000
    buffer_load_dwordx4 v[56:59], v7, s[40:43], s95 offen sc1
    buffer_load_dwordx4 v[60:63], v8, s[40:43], s95 offen sc1
    s_mul_i32 s26, s11, 5120
    s_add_u32 s26, s26, s24
    buffer_load_dwordx4 v[236:239], v14, s[40:43], s26 offen offset:0 sc1
    buffer_load_dwordx4 v[240:243], v14, s[40:43], s26 offen offset:1024 sc1
    buffer_load_dwordx4 v[244:247], v14, s[40:43], s26 offen offset:2048 sc1
    buffer_load_dwordx4 v[248:251], v14, s[40:43], s26 offen offset:3072 sc1
    buffer_load_dwordx4 v[252:255], v15, s[40:43], s26 offen sc1
    s_mul_i32 s27, s12, 5120
    s_add_u32 s27, s27, s24
    buffer_load_dwordx4 a[0:3], v14, s[40:43], s27 offen offset:0 sc1
    buffer_load_dwordx4 a[4:7], v14, s[40:43], s27 offen offset:1024 sc1
    buffer_load_dwordx4 a[8:11], v14, s[40:43], s27 offen offset:2048 sc1
    buffer_load_dwordx4 a[12:15], v14, s[40:43], s27 offen offset:3072 sc1
    buffer_load_dwordx4 a[16:19], v15, s[40:43], s27 offen sc1
    s_waitcnt vmcnt(11)
    v_xor_b32 v64, s64, v57
    v_xor_b32 v65, s64, v59
    s_waitcnt vmcnt(10)
    v_xor_b32 v66, s64, v61
    v_xor_b32 v67, s64, v63
    v_or3_b32 v64, v64, v65, v66
    v_or_b32 v64, v64, v67
    v_cmp_ne_u32 vcc, 0, v64
    s_nop 3
    s_cmp_eq_u64 vcc, 0
    s_cbranch_scc1 L_lbB1_ok
    s_mov_b32 s91, 0
    s_waitcnt vmcnt(0) lgkmcnt(0)
L_lbB1:
    buffer_load_dwordx4 v[56:59], v7, s[40:43], s95 offen sc1
    buffer_load_dwordx4 v[60:63], v8, s[40:43], s95 offen sc1
    s_add_u32 s91, s91, 1
    s_waitcnt vmcnt(1)
    v_xor_b32 v64, s64, v57
    v_xor_b32 v65, s64, v59
    s_waitcnt vmcnt(0)
    v_xor_b32 v66, s64, v61
    v_xor_b32 v67, s64, v63
    v_or3_b32 v64, v64, v65, v66
    v_or_b32 v64, v64, v67
    v_cmp_ne_u32 vcc, 0, v64
    s_nop 3
    s_cmp_eq_u64 vcc, 0
    s_cbranch_scc1 L_lbB1_ok
    s_cmp_lt_u32 s91, 0x30d40
    s_cbranch_scc1 L_lbB1
L_lbB1_ok:
    v_mul_f32 v64, v41, v56
    v_mul_f32 v65, v41, v58
    v_fma_f32 v64, -v42, v58, v64
    v_fmac_f32 v65, v42, v56
    v_fmac_f32 v64, v43, v60
    v_fmac_f32 v65, v43, v62
    v_fma_f32 v64, -v44, v62, v64
    v_fmac_f32 v65, v44, v60
    ds_write_b64 v9, v[64:65] offset:9216
    s_waitcnt lgkmcnt(0)
    s_barrier
    ds_read_b128 v[56:59], v10 offset:9216
    ds_read_b128 v[60:63], v10 offset:9232
    ds_read_b128 v[64:67], v10 offset:9248
    ds_read_b128 v[68:71], v10 offset:9264
    s_waitcnt lgkmcnt(3)
    v_add_f32 v56, v56, v58
    v_add_f32 v57, v57, v59
    s_waitcnt lgkmcnt(2)
    v_add_f32 v60, v60, v62
    v_add_f32 v61, v61, v63
    s_waitcnt lgkmcnt(1)
    v_add_f32 v64, v64, v66
    v_add_f32 v65, v65, v67
    s_mul_i32 s27, s13, 5120
    s_add_u32 s27, s27, s24
    buffer_load_dwordx4 a[20:23], v14, s[40:43], s27 offen offset:0 sc1
    s_waitcnt lgkmcnt(0)
    v_add_f32 v68, v68, v70
    v_add_f32 v69, v69, v71
    v_add_f32 v56, v56, v60
    v_add_f32 v57, v57, v61
    v_add_f32 v64, v64, v68
    v_add_f32 v65, v65, v69
    v_add_f32 v56, v56, v64
    v_add_f32 v57, v57, v65
    v_fmac_f32 v52, v39, v56
    v_fmac_f32 v53, v39, v57
    buffer_load_dwordx4 a[24:27], v14, s[40:43], s27 offen offset:1024 sc1
    v_fma_f32 v52, -v40, v57, v52
    v_fmac_f32 v53, v40, v56
    v_mul_f32 v58, v45, v52
    v_mul_f32 v59, v45, v53
    v_fma_f32 v58, -v46, v53, v58
    v_fmac_f32 v59, v46, v52
    v_fmac_f32 v160, v34, v58
    v_fmac_f32 v176, v34, v59
    v_fmac_f32 v160, v36, v59
    v_fmac_f32 v176, v35, v58
    buffer_load_dwordx4 a[28:31], v14, s[40:43], s27 offen offset:2048 sc1
    v_fmac_f32 v161, v34, v160
    v_fmac_f32 v177, v34, v176
    v_fmac_f32 v161, v36, v176
    v_fmac_f32 v177, v35, v160
    v_fmac_f32 v162, v34, v161
    v_fmac_f32 v178, v34, v177
    v_fmac_f32 v162, v36, v177
    v_fmac_f32 v178, v35, v161
    v_fmac_f32 v163, v34, v162
    v_fmac_f32 v179, v34, v178
    buffer_load_dwordx4 a[32:35], v14, s[40:43], s27 offen offset:3072 sc1
    v_fmac_f32 v163, v36, v178
    v_fmac_f32 v179, v35, v162
    v_fmac_f32 v164, v34, v163
    v_fmac_f32 v180, v34, v179
    v_fmac_f32 v164, v36, v179
    v_fmac_f32 v180, v35, v163
    v_fmac_f32 v165, v34, v164
    v_fmac_f32 v181, v34, v180
    v_fmac_f32 v165, v36, v180
    v_fmac_f32 v181, v35, v164
    buffer_load_dwordx4 a[36:39], v15, s[40:43], s27 offen sc1
    v_fmac_f32 v166, v34, v165
    v_fmac_f32 v182, v34, v181
    v_fmac_f32 v166, v36, v181
    v_fmac_f32 v182, v35, v165
    v_fmac_f32 v167, v34, v166
    v_fmac_f32 v183, v34, v182
    v_fmac_f32 v167, v36, v182
    v_fmac_f32 v183, v35, v166
    v_fmac_f32 v168, v34, v167
    v_fmac_f32 v184, v34, v183
    s_mul_i32 s27, s14, 5120
    s_add_u32 s27, s27, s24
    buffer_load_dwordx4 a[40:43], v14, s[40:43], s27 offen offset:0 sc1
    v_fmac_f32 v168, v36, v183
    v_fmac_f32 v184, v35, v167
    v_fmac_f32 v169, v34, v168
    v_fmac_f32 v185, v34, v184
    v_fmac_f32 v169, v36, v184
    v_fmac_f32 v185, v35, v168
    v_fmac_f32 v170, v34, v169
    v_fmac_f32 v186, v34, v185
    v_fmac_f32 v170, v36, v185
    v_fmac_f32 v186, v35, v169
    buffer_load_dwordx4 a[44:47], v14, s[40:43], s27 offen offset:1024 sc1
    v_fmac_f32 v171, v34, v170
    v_fmac_f32 v187, v34, v186
    v_fmac_f32 v171, v36, v186
    v_fmac_f32 v187, v35, v170
    v_fmac_f32 v172, v34, v171
    v_fmac_f32 v188, v34, v187
    v_fmac_f32 v172, v36, v187
    v_fmac_f32 v188, v35, v171
    v_fmac_f32 v173, v34, v172
    v_fmac_f32 v189, v34, v188
    buffer_load_dwordx4 a[48:51], v14, s[40:43], s27 offen offset:2048 sc1
    v_fmac_f32 v173, v36, v188
    v_fmac_f32 v189, v35, v172
    v_fmac_f32 v174, v34, v173
    v_fmac_f32 v190, v34, v189
    v_fmac_f32 v174, v36, v189
    v_fmac_f32 v190, v35, v173
    v_fmac_f32 v175, v34, v174
    v_fmac_f32 v191, v34, v190
    v_fmac_f32 v175, v36, v190
    v_fmac_f32 v191, v35, v174
    buffer_load_dwordx4 a[52:55], v14, s[40:43], s27 offen offset:3072 sc1
    v_cvt_pk_bf16_f32 v160, v160, v161
    v_cvt_pk_bf16_f32 v161, v162, v163
    v_cvt_pk_bf16_f32 v162, v164, v165
    v_cvt_pk_bf16_f32 v163, v166, v167
    v_cvt_pk_bf16_f32 v164, v168, v169
    v_cvt_pk_bf16_f32 v165, v170, v171
    v_cvt_pk_bf16_f32 v166, v172, v173
    v_cvt_pk_bf16_f32 v167, v174, v175
    v_cvt_pk_bf16_f32 v168, -v176, -v177
    v_cvt_pk_bf16_f32 v169, -v178, -v179
    buffer_load_dwordx4 a[56:59], v15, s[40:43], s27 offen sc1
    v_cvt_pk_bf16_f32 v170, -v180, -v181
    v_cvt_pk_bf16_f32 v171, -v182, -v183
    v_cvt_pk_bf16_f32 v172, -v184, -v185
    v_cvt_pk_bf16_f32 v173, -v186, -v187
    v_cvt_pk_bf16_f32 v174, -v188, -v189
    v_cvt_pk_bf16_f32 v175, -v190, -v191
    v_mfma_f32_32x32x16_bf16 v[96:111], v[160:163], v[72:75], 0
    v_mfma_f32_32x32x16_bf16 v[112:127], v[168:171], v[72:75], 0
    v_mfma_f32_32x32x16_bf16 v[96:111], v[164:167], v[76:79], v[96:111]
    v_mfma_f32_32x32x16_bf16 v[112:127], v[172:175], v[76:79], v[112:127]
    s_add_u32 s94, s23, 200704
    s_add_u32 s95, s23, 282624
    s_nop 8
    v_cvt_pk_bf16_f32 v96, v96, v97
    v_cvt_pk_bf16_f32 v97, v98, v99
    v_cvt_pk_bf16_f32 v98, v100, v101
    v_cvt_pk_bf16_f32 v99, v102, v103
    v_cvt_pk_bf16_f32 v100, v104, v105
    v_cvt_pk_bf16_f32 v101, v106, v107
    v_cvt_pk_bf16_f32 v102, v108, v109
    v_cvt_pk_bf16_f32 v103, v110, v111
    buffer_store_dwordx4 v[96:99], v5, s[40:43], s94 offen sc1
    buffer_store_dwordx4 v[100:103], v5, s[40:43], s94 offen offset:512 sc1
    v_cvt_pk_bf16_f32 v112, v112, v113
    v_cvt_pk_bf16_f32 v113, v114, v115
    v_cvt_pk_bf16_f32 v114, v116, v117
    v_cvt_pk_bf16_f32 v115, v118, v119
    v_cvt_pk_bf16_f32 v116, v120, v121
    v_cvt_pk_bf16_f32 v117, v122, v123
    v_cvt_pk_bf16_f32 v118, v124, v125
    v_cvt_pk_bf16_f32 v119, v126, v127
    buffer_store_dwordx4 v[112:115], v5, s[40:43], s95 offen sc1
    buffer_store_dwordx4 v[116:119], v5, s[40:43], s95 offen offset:512 sc1
    s_mul_i32 s27, s15, 5120
    s_add_u32 s27, s27, s24
    buffer_load_dwordx4 a[60:63], v14, s[40:43], s27 offen offset:0 sc1
    buffer_load_dwordx4 a[64:67], v14, s[40:43], s27 offen offset:1024 sc1
    buffer_load_dwordx4 a[68:71], v14, s[40:43], s27 offen offset:2048 sc1
    buffer_load_dwordx4 a[72:75], v14, s[40:43], s27 offen offset:3072 sc1
    buffer_load_dwordx4 a[76:79], v15, s[40:43], s27 offen sc1
    s_mul_i32 s27, s16, 5120
    s_add_u32 s27, s27, s24
    buffer_load_dwordx4 a[80:83], v14, s[40:43], s27 offen offset:0 sc1
    buffer_load_dwordx4 a[84:87], v14, s[40:43], s27 offen offset:1024 sc1
    buffer_load_dwordx4 a[88:91], v14, s[40:43], s27 offen offset:2048 sc1
    buffer_load_dwordx4 a[92:95], v14, s[40:43], s27 offen offset:3072 sc1
    buffer_load_dwordx4 a[96:99], v15, s[40:43], s27 offen sc1
    s_waitcnt vmcnt(10)
    v_mov_b32 v96, s64
    v_mov_b32 v97, s65
    s_lshl_b32 s90, s67, 2
    s_add_u32 s90, s90, s66
    s_lshl_b32 s90, s90, 4
    s_add_u32 s90, s90, s72
    s_lshl_b32 s90, s90, 3
    s_add_u32 s90, s90, 0x1000
    v_mov_b32 v98, 0
    buffer_store_dwordx2 v[96:97], v98, s[40:43], s90 offen sc1
    s_waitcnt lgkmcnt(0)
L_phase2:
    s_mov_b32 s96, s29
    s_cmp_lt_u32 s96, 10
    s_cselect_b32 s95, s34, s35
    s_add_u32 s52, s95, s96
    s_add_u32 s96, s96, 1
    s_cmp_eq_u32 s96, 22
    s_cselect_b32 s96, 0, s96
    s_cmp_lt_u32 s96, 10
    s_cselect_b32 s95, s34, s35
    s_add_u32 s53, s95, s96
    s_add_u32 s96, s96, 1
    s_cmp_eq_u32 s96, 22
    s_cselect_b32 s96, 0, s96
    s_cmp_lt_u32 s96, 10
    s_cselect_b32 s95, s34, s35
    s_add_u32 s54, s95, s96
    s_add_u32 s96, s96, 1
    s_cmp_eq_u32 s96, 22
    s_cselect_b32 s96, 0, s96
    s_cmp_lt_u32 s96, 10
    s_cselect_b32 s95, s34, s35
    s_add_u32 s55, s95, s96
    s_add_u32 s96, s96, 1
    s_cmp_eq_u32 s96, 22
    s_cselect_b32 s96, 0, s96
    s_cmp_lt_u32 s96, 10
    s_cselect_b32 s95, s34, s35
    s_add_u32 s56, s95, s96
    s_add_u32 s96, s96, 1
    s_cmp_eq_u32 s96, 22
    s_cselect_b32 s96, 0, s96
    s_cmp_lt_u32 s96, 10
    s_cselect_b32 s95, s34, s35
    s_add_u32 s57, s95, s96
    s_add_u32 s96, s96, 1
    s_cmp_eq_u32 s96, 22
    s_cselect_b32 s96, 0, s96
    s_barrier
    s_mov_b32 s48, s30
    s_and_b32 s49, s31, 0xffff
    s_mov_b32 s50, 0x500000
    s_mov_b32 s51, 0x20000
    s_add_u32 s90, s66, 0
    s_and_b32 s90, s90, 3
    s_lshl_b32 s91, s90, 10
    v_add_u32 v1, s91, v14
    s_add_u32 s90, s66, 1
    s_and_b32 s90, s90, 3
    s_lshl_b32 s91, s90, 10
    v_add_u32 v2, s91, v14
    s_mul_i32 s91, s90, 15360
    s_add_u32 s91, s91, 0
    v_add_u32 v5, s91, v14
    s_add_u32 s90, s66, 2
    s_and_b32 s90, s90, 3
    s_lshl_b32 s91, s90, 10
    v_add_u32 v3, s91, v14
    s_mul_i32 s91, s90, 15360
    s_add_u32 s91, s91, 5120
    v_add_u32 v6, s91, v14
    s_add_u32 s90, s66, 3
    s_and_b32 s90, s90, 3
    s_lshl_b32 s91, s90, 10
    v_add_u32 v4, s91, v14
    s_mul_i32 s91, s90, 15360
    s_add_u32 s91, s91, 10240
    v_add_u32 v7, s91, v14
    s_mul_i32 s91, s66, 15360
    v_add_u32 v8, s91, v14
    v_and_b32 v98, 15, v0
    v_lshrrev_b32 v13, 4, v0
    v_bfe_u32 v120, v98, 2, 1
    v_lshlrev_b32 v120, 4, v120
    v_and_b32 v96, 3, v98
    v_add_u32 v120, v120, v96
    v_lshrrev_b32 v96, 3, v98
    v_lshl_add_u32 v120, v96, 2, v120
    s_lshr_b32 s90, s66, 1
    s_lshl_b32 s90, s90, 5
    s_and_b32 s91, s66, 1
    s_lshl_b32 s91, s91, 3
    s_add_u32 s90, s90, s91
    v_add_u32 v120, s90, v120
    v_mul_u32_u24 v9, 2560, v120
    v_lshl_add_u32 v9, v13, 4, v9
    v_mul_u32_u24 v10, 1280, v120
    v_lshl_add_u32 v10, v13, 3, v10
    s_mul_i32 s90, s71, 160
    v_lshlrev_b32 v11, 3, v13
    v_add_u32 v11, s90, v11
    s_and_b32 s90, s70, 1
    s_lshl_b32 s90, s90, 6
    v_add_u32 v12, s90, v120
    v_lshlrev_b32 v12, 2, v12
    v_add_u32 v12, 149504, v12
    s_mul_i32 s90, s70, 81920
    s_mul_i32 s91, s71, 160
    s_add_u32 s90, s90, s91
    buffer_load_dwordx2 v[100:101], v10, s[36:39], s90 offen offset:0
    global_load_dwordx2 v[110:111], v11, s[20:21] offset:0
    buffer_load_dwordx2 v[102:103], v10, s[36:39], s90 offen offset:32
    global_load_dwordx2 v[112:113], v11, s[20:21] offset:32
    buffer_load_dwordx2 v[104:105], v10, s[36:39], s90 offen offset:64
    global_load_dwordx2 v[114:115], v11, s[20:21] offset:64
    buffer_load_dwordx2 v[106:107], v10, s[36:39], s90 offen offset:96
    global_load_dwordx2 v[116:117], v11, s[20:21] offset:96
    buffer_load_dwordx2 v[108:109], v10, s[36:39], s90 offen offset:128
    global_load_dwordx2 v[118:119], v11, s[20:21] offset:128
    s_mul_i32 s26, s17, 5120
    s_add_u32 s26, s26, s24
    buffer_load_dwordx4 a[100:103], v14, s[40:43], s26 offen offset:0 sc1
    buffer_load_dwordx4 a[104:107], v14, s[40:43], s26 offen offset:1024 sc1
    buffer_load_dwordx4 a[108:111], v14, s[40:43], s26 offen offset:2048 sc1
    buffer_load_dwordx4 a[112:115], v14, s[40:43], s26 offen offset:3072 sc1
    buffer_load_dwordx4 a[116:119], v15, s[40:43], s26 offen sc1
    s_mul_i32 s26, s18, 5120
    s_add_u32 s26, s26, s24
    buffer_load_dwordx4 a[120:123], v14, s[40:43], s26 offen offset:0 sc1
    buffer_load_dwordx4 a[124:127], v14, s[40:43], s26 offen offset:1024 sc1
    buffer_load_dwordx4 a[128:131], v14, s[40:43], s26 offen offset:2048 sc1
    buffer_load_dwordx4 a[132:135], v14, s[40:43], s26 offen offset:3072 sc1
    buffer_load_dwordx4 a[136:139], v15, s[40:43], s26 offen sc1
    s_mul_i32 s26, s19, 5120
    s_add_u32 s26, s26, s24
    buffer_load_dwordx4 a[140:143], v14, s[40:43], s26 offen offset:0 sc1
    buffer_load_dwordx4 a[144:147], v14, s[40:43], s26 offen offset:1024 sc1
    buffer_load_dwordx4 a[148:151], v14, s[40:43], s26 offen offset:2048 sc1
    buffer_load_dwordx4 a[152:155], v14, s[40:43], s26 offen offset:3072 sc1
    buffer_load_dwordx4 a[156:159], v15, s[40:43], s26 offen sc1
    s_lshl_b32 s90, s67, 2
    s_and_b32 s95, s70, 1
    s_lshl_b32 s95, s95, 1
    s_add_u32 s90, s90, s95
    s_lshl_b32 s90, s90, 7
    s_add_u32 s95, s90, 0x1000
    v_and_b32 v98, 31, v0
    v_lshlrev_b32 v98, 3, v98
    buffer_load_dwordx2 v[96:97], v98, s[40:43], s95 offen sc1
    ds_read_b32 v12, v12
    s_waitcnt vmcnt(0)
    v_xor_b32 v96, s64, v96
    v_xor_b32 v97, s65, v97
    v_or_b32 v96, v96, v97
    v_cmp_ne_u32 vcc, 0, v96
    s_nop 3
    s_cmp_eq_u64 vcc, 0
    s_cbranch_scc1 L_pfl_ok
    s_mov_b32 s91, 0
    s_waitcnt vmcnt(0) lgkmcnt(0)
L_pfl:
    buffer_load_dwordx2 v[96:97], v98, s[40:43], s95 offen sc1
    s_add_u32 s91, s91, 1
    s_waitcnt vmcnt(0)
    v_xor_b32 v96, s64, v96
    v_xor_b32 v97, s65, v97
    v_or_b32 v96, v96, v97
    v_cmp_ne_u32 vcc, 0, v96
    s_nop 3
    s_cmp_eq_u64 vcc, 0
    s_cbranch_scc1 L_pfl_ok
    s_cmp_lt_u32 s91, 0x30d40
    s_cbranch_scc1 L_pfl
L_pfl_ok:
    s_cmp_lg_u32 s70, 31
    s_cbranch_scc1 L_noep
    s_cmp_lg_u32 s71, 0
    s_cbranch_scc1 L_noep
    v_mov_b32 v120, s64
    v_mov_b32 v98, 0x0
    buffer_store_dword v120, v98, s[40:43], 0 offen sc1
    s_waitcnt vmcnt(0)
L_noep:
    s_lshl_b32 s27, s4, 12
    s_add_u32 s27, s27, s25
    buffer_load_dwordx4 v[124:127], v1, s[40:43], s27 offen sc1
    buffer_load_dwordx4 v[128:131], v2, s[40:43], s27 offen sc1
    buffer_load_dwordx4 v[132:135], v3, s[40:43], s27 offen sc1
    buffer_load_dwordx4 v[136:139], v4, s[40:43], s27 offen sc1
    s_lshl_b32 s27, s5, 12
    s_add_u32 s27, s27, s25
    buffer_load_dwordx4 v[140:143], v1, s[40:43], s27 offen sc1
    buffer_load_dwordx4 v[144:147], v2, s[40:43], s27 offen sc1
    buffer_load_dwordx4 v[148:151], v3, s[40:43], s27 offen sc1
    buffer_load_dwordx4 v[152:155], v4, s[40:43], s27 offen sc1
    s_lshl_b32 s27, s6, 12
    s_add_u32 s27, s27, s25
    buffer_load_dwordx4 v[156:159], v1, s[40:43], s27 offen sc1
    buffer_load_dwordx4 v[160:163], v2, s[40:43], s27 offen sc1
    buffer_load_dwordx4 v[164:167], v3, s[40:43], s27 offen sc1
    buffer_load_dwordx4 v[168:171], v4, s[40:43], s27 offen sc1
    s_lshl_b32 s27, s7, 12
    s_add_u32 s27, s27, s25
    buffer_load_dwordx4 v[172:175], v1, s[40:43], s27 offen sc1
    buffer_load_dwordx4 v[176:179], v2, s[40:43], s27 offen sc1
    buffer_load_dwordx4 v[180:183], v3, s[40:43], s27 offen sc1
    buffer_load_dwordx4 v[184:187], v4, s[40:43], s27 offen sc1
    s_waitcnt vmcnt(15)
    v_mfma_f32_16x16x32_bf16 v[16:19], a[160:163], v[124:127], 0
    s_lshl_b32 s27, s8, 12
    s_add_u32 s27, s27, s25
    buffer_load_dwordx4 v[188:191], v1, s[40:43], s27 offen sc1
    s_waitcnt vmcnt(15)
    v_mfma_f32_16x16x32_bf16 v[20:23], a[160:163], v[128:131], 0
    s_waitcnt vmcnt(14)
    v_mfma_f32_16x16x32_bf16 v[24:27], a[160:163], v[132:135], 0
    s_waitcnt vmcnt(13)
    v_mfma_f32_16x16x32_bf16 v[28:31], a[160:163], v[136:139], 0
    v_mfma_f32_16x16x32_bf16 v[32:35], a[164:167], v[124:127], 0
    v_mfma_f32_16x16x32_bf16 v[36:39], a[164:167], v[128:131], 0
    v_mfma_f32_16x16x32_bf16 v[40:43], a[164:167], v[132:135], 0
    v_mfma_f32_16x16x32_bf16 v[44:47], a[164:167], v[136:139], 0
    v_mfma_f32_16x16x32_bf16 v[48:51], a[168:171], v[124:127], 0
    v_mfma_f32_16x16x32_bf16 v[52:55], a[168:171], v[128:131], 0
    v_mfma_f32_16x16x32_bf16 v[56:59], a[168:171], v[132:135], 0
    v_mfma_f32_16x16x32_bf16 v[60:63], a[168:171], v[136:139], 0
    v_mfma_f32_16x16x32_bf16 v[64:67], a[172:175], v[124:127], 0
    v_mfma_f32_16x16x32_bf16 v[68:71], a[172:175], v[128:131], 0
    v_mfma_f32_16x16x32_bf16 v[72:75], a[172:175], v[132:135], 0
    v_mfma_f32_16x16x32_bf16 v[76:79], a[172:175], v[136:139], 0
    v_mfma_f32_16x16x32_bf16 v[80:83], a[176:179], v[124:127], 0
    v_mfma_f32_16x16x32_bf16 v[84:87], a[176:179], v[128:131], 0
    v_mfma_f32_16x16x32_bf16 v[88:91], a[176:179], v[132:135], 0
    v_mfma_f32_16x16x32_bf16 v[92:95], a[176:179], v[136:139], 0
    s_waitcnt vmcnt(12)
    v_mfma_f32_16x16x32_bf16 v[16:19], a[180:183], v[140:143], v[16:19]
    buffer_load_dwordx4 a[160:163], v2, s[40:43], s27 offen sc1
    s_waitcnt vmcnt(12)
    v_mfma_f32_16x16x32_bf16 v[20:23], a[180:183], v[144:147], v[20:23]
    buffer_load_dwordx4 a[164:167], v3, s[40:43], s27 offen sc1
    s_waitcnt vmcnt(12)
    v_mfma_f32_16x16x32_bf16 v[24:27], a[180:183], v[148:151], v[24:27]
    s_waitcnt vmcnt(11)
    v_mfma_f32_16x16x32_bf16 v[28:31], a[180:183], v[152:155], v[28:31]
    v_mfma_f32_16x16x32_bf16 v[32:35], a[184:187], v[140:143], v[32:35]
    buffer_load_dwordx4 a[168:171], v4, s[40:43], s27 offen sc1
    v_mfma_f32_16x16x32_bf16 v[36:39], a[184:187], v[144:147], v[36:39]
    v_mfma_f32_16x16x32_bf16 v[40:43], a[184:187], v[148:151], v[40:43]
    v_mfma_f32_16x16x32_bf16 v[44:47], a[184:187], v[152:155], v[44:47]
    s_lshl_b32 s27, s9, 12
    s_add_u32 s27, s27, s25
    buffer_load_dwordx4 a[172:175], v1, s[40:43], s27 offen sc1
    v_mfma_f32_16x16x32_bf16 v[48:51], a[188:191], v[140:143], v[48:51]
    v_mfma_f32_16x16x32_bf16 v[52:55], a[188:191], v[144:147], v[52:55]
    v_mfma_f32_16x16x32_bf16 v[56:59], a[188:191], v[148:151], v[56:59]
    v_mfma_f32_16x16x32_bf16 v[60:63], a[188:191], v[152:155], v[60:63]
    buffer_load_dwordx4 a[176:179], v2, s[40:43], s27 offen sc1
    v_mfma_f32_16x16x32_bf16 v[64:67], a[192:195], v[140:143], v[64:67]
    v_mfma_f32_16x16x32_bf16 v[68:71], a[192:195], v[144:147], v[68:71]
    v_mfma_f32_16x16x32_bf16 v[72:75], a[192:195], v[148:151], v[72:75]
    buffer_load_dwordx4 v[124:127], v3, s[40:43], s27 offen sc1
    v_mfma_f32_16x16x32_bf16 v[76:79], a[192:195], v[152:155], v[76:79]
    v_mfma_f32_16x16x32_bf16 v[80:83], a[196:199], v[140:143], v[80:83]
    v_mfma_f32_16x16x32_bf16 v[84:87], a[196:199], v[144:147], v[84:87]
    v_mfma_f32_16x16x32_bf16 v[88:91], a[196:199], v[148:151], v[88:91]
    buffer_load_dwordx4 v[128:131], v4, s[40:43], s27 offen sc1
    v_mfma_f32_16x16x32_bf16 v[92:95], a[196:199], v[152:155], v[92:95]
    s_waitcnt vmcnt(15)
    v_mfma_f32_16x16x32_bf16 v[16:19], a[200:203], v[156:159], v[16:19]
    s_waitcnt vmcnt(14)
    v_mfma_f32_16x16x32_bf16 v[20:23], a[200:203], v[160:163], v[20:23]
    s_lshl_b32 s27, s10, 12
    s_add_u32 s27, s27, s25
    buffer_load_dwordx4 v[132:135], v1, s[40:43], s27 offen sc1
    s_waitcnt vmcnt(14)
    v_mfma_f32_16x16x32_bf16 v[24:27], a[200:203], v[164:167], v[24:27]
    s_waitcnt vmcnt(13)
    v_mfma_f32_16x16x32_bf16 v[28:31], a[200:203], v[168:171], v[28:31]
    v_mfma_f32_16x16x32_bf16 v[32:35], a[204:207], v[156:159], v[32:35]
    v_mfma_f32_16x16x32_bf16 v[36:39], a[204:207], v[160:163], v[36:39]
    buffer_load_dwordx4 v[136:139], v2, s[40:43], s27 offen sc1
    v_mfma_f32_16x16x32_bf16 v[40:43], a[204:207], v[164:167], v[40:43]
    v_mfma_f32_16x16x32_bf16 v[44:47], a[204:207], v[168:171], v[44:47]
    v_mfma_f32_16x16x32_bf16 v[48:51], a[208:211], v[156:159], v[48:51]
    buffer_load_dwordx4 a[180:183], v3, s[40:43], s27 offen sc1
    v_mfma_f32_16x16x32_bf16 v[52:55], a[208:211], v[160:163], v[52:55]
    v_mfma_f32_16x16x32_bf16 v[56:59], a[208:211], v[164:167], v[56:59]
    v_mfma_f32_16x16x32_bf16 v[60:63], a[208:211], v[168:171], v[60:63]
    v_mfma_f32_16x16x32_bf16 v[64:67], a[212:215], v[156:159], v[64:67]
    buffer_load_dwordx4 a[184:187], v4, s[40:43], s27 offen sc1
    v_mfma_f32_16x16x32_bf16 v[68:71], a[212:215], v[160:163], v[68:71]
    v_mfma_f32_16x16x32_bf16 v[72:75], a[212:215], v[164:167], v[72:75]
    v_mfma_f32_16x16x32_bf16 v[76:79], a[212:215], v[168:171], v[76:79]
    s_lshl_b32 s27, s11, 12
    s_add_u32 s27, s27, s25
    buffer_load_dwordx4 a[188:191], v1, s[40:43], s27 offen sc1
    v_mfma_f32_16x16x32_bf16 v[80:83], a[216:219], v[156:159], v[80:83]
    v_mfma_f32_16x16x32_bf16 v[84:87], a[216:219], v[160:163], v[84:87]
    v_mfma_f32_16x16x32_bf16 v[88:91], a[216:219], v[164:167], v[88:91]
    v_mfma_f32_16x16x32_bf16 v[92:95], a[216:219], v[168:171], v[92:95]
    buffer_load_dwordx4 a[192:195], v2, s[40:43], s27 offen sc1
    s_waitcnt vmcnt(17)
    v_mfma_f32_16x16x32_bf16 v[16:19], a[220:223], v[172:175], v[16:19]
    s_waitcnt vmcnt(16)
    v_mfma_f32_16x16x32_bf16 v[20:23], a[220:223], v[176:179], v[20:23]
    s_waitcnt vmcnt(15)
    v_mfma_f32_16x16x32_bf16 v[24:27], a[220:223], v[180:183], v[24:27]
    buffer_load_dwordx4 a[196:199], v3, s[40:43], s27 offen sc1
    s_waitcnt vmcnt(15)
    v_mfma_f32_16x16x32_bf16 v[28:31], a[220:223], v[184:187], v[28:31]
    v_mfma_f32_16x16x32_bf16 v[32:35], a[224:227], v[172:175], v[32:35]
    v_mfma_f32_16x16x32_bf16 v[36:39], a[224:227], v[176:179], v[36:39]
    v_mfma_f32_16x16x32_bf16 v[40:43], a[224:227], v[180:183], v[40:43]
    buffer_load_dwordx4 v[140:143], v4, s[40:43], s27 offen sc1
    v_mfma_f32_16x16x32_bf16 v[44:47], a[224:227], v[184:187], v[44:47]
    v_mfma_f32_16x16x32_bf16 v[48:51], a[228:231], v[172:175], v[48:51]
    v_mfma_f32_16x16x32_bf16 v[52:55], a[228:231], v[176:179], v[52:55]
    s_lshl_b32 s27, s12, 12
    s_add_u32 s27, s27, s25
    buffer_load_dwordx4 v[144:147], v1, s[40:43], s27 offen sc1
    v_mfma_f32_16x16x32_bf16 v[56:59], a[228:231], v[180:183], v[56:59]
    v_mfma_f32_16x16x32_bf16 v[60:63], a[228:231], v[184:187], v[60:63]
    v_mfma_f32_16x16x32_bf16 v[64:67], a[232:235], v[172:175], v[64:67]
    v_mfma_f32_16x16x32_bf16 v[68:71], a[232:235], v[176:179], v[68:71]
    buffer_load_dwordx4 v[148:151], v2, s[40:43], s27 offen sc1
    v_mfma_f32_16x16x32_bf16 v[72:75], a[232:235], v[180:183], v[72:75]
    v_mfma_f32_16x16x32_bf16 v[76:79], a[232:235], v[184:187], v[76:79]
    v_mfma_f32_16x16x32_bf16 v[80:83], a[236:239], v[172:175], v[80:83]
    buffer_load_dwordx4 v[152:155], v3, s[40:43], s27 offen sc1
    v_mfma_f32_16x16x32_bf16 v[84:87], a[236:239], v[176:179], v[84:87]
    v_mfma_f32_16x16x32_bf16 v[88:91], a[236:239], v[180:183], v[88:91]
    v_mfma_f32_16x16x32_bf16 v[92:95], a[236:239], v[184:187], v[92:95]
    s_waitcnt vmcnt(18)
    v_mfma_f32_16x16x32_bf16 v[16:19], a[240:243], v[188:191], v[16:19]
    buffer_load_dwordx4 a[200:203], v4, s[40:43], s27 offen sc1
    s_waitcnt vmcnt(18)
    v_mfma_f32_16x16x32_bf16 v[20:23], a[240:243], a[160:163], v[20:23]
    s_waitcnt vmcnt(17)
    v_mfma_f32_16x16x32_bf16 v[24:27], a[240:243], a[164:167], v[24:27]
    s_waitcnt vmcnt(16)
    v_mfma_f32_16x16x32_bf16 v[28:31], a[240:243], a[168:171], v[28:31]
    s_lshl_b32 s27, s13, 12
    s_add_u32 s27, s27, s25
    buffer_load_dwordx4 a[204:207], v1, s[40:43], s27 offen sc1
    v_mfma_f32_16x16x32_bf16 v[32:35], a[244:247], v[188:191], v[32:35]
    v_mfma_f32_16x16x32_bf16 v[36:39], a[244:247], a[160:163], v[36:39]
    v_mfma_f32_16x16x32_bf16 v[40:43], a[244:247], a[164:167], v[40:43]
    v_mfma_f32_16x16x32_bf16 v[44:47], a[244:247], a[168:171], v[44:47]
    buffer_load_dwordx4 a[208:211], v2, s[40:43], s27 offen sc1
    v_mfma_f32_16x16x32_bf16 v[48:51], a[248:251], v[188:191], v[48:51]
    v_mfma_f32_16x16x32_bf16 v[52:55], a[248:251], a[160:163], v[52:55]
    v_mfma_f32_16x16x32_bf16 v[56:59], a[248:251], a[164:167], v[56:59]
    buffer_load_dwordx4 a[212:215], v3, s[40:43], s27 offen sc1
    v_mfma_f32_16x16x32_bf16 v[60:63], a[248:251], a[168:171], v[60:63]
    v_mfma_f32_16x16x32_bf16 v[64:67], a[252:255], v[188:191], v[64:67]
    v_mfma_f32_16x16x32_bf16 v[68:71], a[252:255], a[160:163], v[68:71]
    v_mfma_f32_16x16x32_bf16 v[72:75], a[252:255], a[164:167], v[72:75]
    buffer_load_dwordx4 a[216:219], v4, s[40:43], s27 offen sc1
    v_mfma_f32_16x16x32_bf16 v[76:79], a[252:255], a[168:171], v[76:79]
    v_mfma_f32_16x16x32_bf16 v[80:83], v[192:195], v[188:191], v[80:83]
    v_mfma_f32_16x16x32_bf16 v[84:87], v[192:195], a[160:163], v[84:87]
    s_lshl_b32 s27, s14, 12
    s_add_u32 s27, s27, s25
    buffer_load_dwordx4 v[156:159], v1, s[40:43], s27 offen sc1
    v_mfma_f32_16x16x32_bf16 v[88:91], v[192:195], a[164:167], v[88:91]
    v_mfma_f32_16x16x32_bf16 v[92:95], v[192:195], a[168:171], v[92:95]
    s_waitcnt vmcnt(20)
    v_mfma_f32_16x16x32_bf16 v[16:19], v[196:199], a[172:175], v[16:19]
    s_waitcnt vmcnt(19)
    v_mfma_f32_16x16x32_bf16 v[20:23], v[196:199], a[176:179], v[20:23]
    buffer_load_dwordx4 v[160:163], v2, s[40:43], s27 offen sc1
    s_waitcnt vmcnt(19)
    v_mfma_f32_16x16x32_bf16 v[24:27], v[196:199], v[124:127], v[24:27]
    s_waitcnt vmcnt(18)
    v_mfma_f32_16x16x32_bf16 v[28:31], v[196:199], v[128:131], v[28:31]
    v_mfma_f32_16x16x32_bf16 v[32:35], v[200:203], a[172:175], v[32:35]
    buffer_load_dwordx4 v[164:167], v3, s[40:43], s27 offen sc1
    v_mfma_f32_16x16x32_bf16 v[36:39], v[200:203], a[176:179], v[36:39]
    v_mfma_f32_16x16x32_bf16 v[40:43], v[200:203], v[124:127], v[40:43]
    v_mfma_f32_16x16x32_bf16 v[44:47], v[200:203], v[128:131], v[44:47]
    v_mfma_f32_16x16x32_bf16 v[48:51], v[204:207], a[172:175], v[48:51]
    buffer_load_dwordx4 v[168:171], v4, s[40:43], s27 offen sc1
    v_mfma_f32_16x16x32_bf16 v[52:55], v[204:207], a[176:179], v[52:55]
    v_mfma_f32_16x16x32_bf16 v[56:59], v[204:207], v[124:127], v[56:59]
    v_mfma_f32_16x16x32_bf16 v[60:63], v[204:207], v[128:131], v[60:63]
    s_lshl_b32 s27, s15, 12
    s_add_u32 s27, s27, s25
    buffer_load_dwordx4 a[220:223], v1, s[40:43], s27 offen sc1
    v_mfma_f32_16x16x32_bf16 v[64:67], v[208:211], a[172:175], v[64:67]
    v_mfma_f32_16x16x32_bf16 v[68:71], v[208:211], a[176:179], v[68:71]
    v_mfma_f32_16x16x32_bf16 v[72:75], v[208:211], v[124:127], v[72:75]
    v_mfma_f32_16x16x32_bf16 v[76:79], v[208:211], v[128:131], v[76:79]
    buffer_load_dwordx4 a[224:227], v2, s[40:43], s27 offen sc1
    v_mfma_f32_16x16x32_bf16 v[80:83], v[212:215], a[172:175], v[80:83]
    v_mfma_f32_16x16x32_bf16 v[84:87], v[212:215], a[176:179], v[84:87]
    v_mfma_f32_16x16x32_bf16 v[88:91], v[212:215], v[124:127], v[88:91]
    buffer_load_dwordx4 a[228:231], v3, s[40:43], s27 offen sc1
    v_mfma_f32_16x16x32_bf16 v[92:95], v[212:215], v[128:131], v[92:95]
    s_waitcnt vmcnt(22)
    v_mfma_f32_16x16x32_bf16 v[16:19], v[216:219], v[132:135], v[16:19]
    s_waitcnt vmcnt(21)
    v_mfma_f32_16x16x32_bf16 v[20:23], v[216:219], v[136:139], v[20:23]
    s_waitcnt vmcnt(20)
    v_mfma_f32_16x16x32_bf16 v[24:27], v[216:219], a[180:183], v[24:27]
    buffer_load_dwordx4 a[232:235], v4, s[40:43], s27 offen sc1
    s_waitcnt vmcnt(20)
    v_mfma_f32_16x16x32_bf16 v[28:31], v[216:219], a[184:187], v[28:31]
    v_mfma_f32_16x16x32_bf16 v[32:35], v[220:223], v[132:135], v[32:35]
    v_mfma_f32_16x16x32_bf16 v[36:39], v[220:223], v[136:139], v[36:39]
    s_lshl_b32 s27, s16, 12
    s_add_u32 s27, s27, s25
    buffer_load_dwordx4 a[236:239], v1, s[40:43], s27 offen sc1
    v_mfma_f32_16x16x32_bf16 v[40:43], v[220:223], a[180:183], v[40:43]
    v_mfma_f32_16x16x32_bf16 v[44:47], v[220:223], a[184:187], v[44:47]
    v_mfma_f32_16x16x32_bf16 v[48:51], v[224:227], v[132:135], v[48:51]
    v_mfma_f32_16x16x32_bf16 v[52:55], v[224:227], v[136:139], v[52:55]
    buffer_load_dwordx4 v[172:175], v2, s[40:43], s27 offen sc1
    v_mfma_f32_16x16x32_bf16 v[56:59], v[224:227], a[180:183], v[56:59]
    v_mfma_f32_16x16x32_bf16 v[60:63], v[224:227], a[184:187], v[60:63]
    v_mfma_f32_16x16x32_bf16 v[64:67], v[228:231], v[132:135], v[64:67]
    buffer_load_dwordx4 v[176:179], v3, s[40:43], s27 offen sc1
    v_mfma_f32_16x16x32_bf16 v[68:71], v[228:231], v[136:139], v[68:71]
    v_mfma_f32_16x16x32_bf16 v[72:75], v[228:231], a[180:183], v[72:75]
    v_mfma_f32_16x16x32_bf16 v[76:79], v[228:231], a[184:187], v[76:79]
    v_mfma_f32_16x16x32_bf16 v[80:83], v[232:235], v[132:135], v[80:83]
    buffer_load_dwordx4 v[180:183], v4, s[40:43], s27 offen sc1
    v_mfma_f32_16x16x32_bf16 v[84:87], v[232:235], v[136:139], v[84:87]
    v_mfma_f32_16x16x32_bf16 v[88:91], v[232:235], a[180:183], v[88:91]
    v_mfma_f32_16x16x32_bf16 v[92:95], v[232:235], a[184:187], v[92:95]
    s_lshl_b32 s27, s17, 12
    s_add_u32 s27, s27, s25
    buffer_load_dwordx4 v[184:187], v1, s[40:43], s27 offen sc1
    s_waitcnt vmcnt(24)
    v_mfma_f32_16x16x32_bf16 v[16:19], v[236:239], a[188:191], v[16:19]
    s_waitcnt vmcnt(23)
    v_mfma_f32_16x16x32_bf16 v[20:23], v[236:239], a[192:195], v[20:23]
    s_waitcnt vmcnt(22)
    v_mfma_f32_16x16x32_bf16 v[24:27], v[236:239], a[196:199], v[24:27]
    s_waitcnt vmcnt(21)
    v_mfma_f32_16x16x32_bf16 v[28:31], v[236:239], v[140:143], v[28:31]
    buffer_load_dwordx4 a[240:243], v2, s[40:43], s27 offen sc1
    v_mfma_f32_16x16x32_bf16 v[32:35], v[240:243], a[188:191], v[32:35]
    v_mfma_f32_16x16x32_bf16 v[36:39], v[240:243], a[192:195], v[36:39]
    v_mfma_f32_16x16x32_bf16 v[40:43], v[240:243], a[196:199], v[40:43]
    buffer_load_dwordx4 a[244:247], v3, s[40:43], s27 offen sc1
    v_mfma_f32_16x16x32_bf16 v[44:47], v[240:243], v[140:143], v[44:47]
    v_mfma_f32_16x16x32_bf16 v[48:51], v[244:247], a[188:191], v[48:51]
    v_mfma_f32_16x16x32_bf16 v[52:55], v[244:247], a[192:195], v[52:55]
    v_mfma_f32_16x16x32_bf16 v[56:59], v[244:247], a[196:199], v[56:59]
    buffer_load_dwordx4 a[248:251], v4, s[40:43], s27 offen sc1
    v_mfma_f32_16x16x32_bf16 v[60:63], v[244:247], v[140:143], v[60:63]
    v_mfma_f32_16x16x32_bf16 v[64:67], v[248:251], a[188:191], v[64:67]
    v_mfma_f32_16x16x32_bf16 v[68:71], v[248:251], a[192:195], v[68:71]
    s_lshl_b32 s27, s18, 12
    s_add_u32 s27, s27, s25
    buffer_load_dwordx4 a[252:255], v1, s[40:43], s27 offen sc1
    v_mfma_f32_16x16x32_bf16 v[72:75], v[248:251], a[196:199], v[72:75]
    v_mfma_f32_16x16x32_bf16 v[76:79], v[248:251], v[140:143], v[76:79]
    v_mfma_f32_16x16x32_bf16 v[80:83], v[252:255], a[188:191], v[80:83]
    v_mfma_f32_16x16x32_bf16 v[84:87], v[252:255], a[192:195], v[84:87]
    buffer_load_dwordx4 v[192:195], v2, s[40:43], s27 offen sc1
    v_mfma_f32_16x16x32_bf16 v[88:91], v[252:255], a[196:199], v[88:91]
    v_mfma_f32_16x16x32_bf16 v[92:95], v[252:255], v[140:143], v[92:95]
    s_waitcnt vmcnt(25)
    v_mfma_f32_16x16x32_bf16 v[16:19], a[0:3], v[144:147], v[16:19]
    buffer_load_dwordx4 v[188:191], v3, s[40:43], s27 offen sc1
    s_waitcnt vmcnt(25)
    v_mfma_f32_16x16x32_bf16 v[20:23], a[0:3], v[148:151], v[20:23]
    s_waitcnt vmcnt(24)
    v_mfma_f32_16x16x32_bf16 v[24:27], a[0:3], v[152:155], v[24:27]
    s_waitcnt vmcnt(23)
    v_mfma_f32_16x16x32_bf16 v[28:31], a[0:3], a[200:203], v[28:31]
    v_mfma_f32_16x16x32_bf16 v[32:35], a[4:7], v[144:147], v[32:35]
    buffer_load_dwordx4 a[160:163], v4, s[40:43], s27 offen sc1
    v_mfma_f32_16x16x32_bf16 v[36:39], a[4:7], v[148:151], v[36:39]
    v_mfma_f32_16x16x32_bf16 v[40:43], a[4:7], v[152:155], v[40:43]
    v_mfma_f32_16x16x32_bf16 v[44:47], a[4:7], a[200:203], v[44:47]
    s_lshl_b32 s27, s19, 12
    s_add_u32 s27, s27, s25
    buffer_load_dwordx4 a[164:167], v1, s[40:43], s27 offen sc1
    v_mfma_f32_16x16x32_bf16 v[48:51], a[8:11], v[144:147], v[48:51]
    v_mfma_f32_16x16x32_bf16 v[52:55], a[8:11], v[148:151], v[52:55]
    v_mfma_f32_16x16x32_bf16 v[56:59], a[8:11], v[152:155], v[56:59]
    v_mfma_f32_16x16x32_bf16 v[60:63], a[8:11], a[200:203], v[60:63]
    buffer_load_dwordx4 a[168:171], v2, s[40:43], s27 offen sc1
    v_mfma_f32_16x16x32_bf16 v[64:67], a[12:15], v[144:147], v[64:67]
    v_mfma_f32_16x16x32_bf16 v[68:71], a[12:15], v[148:151], v[68:71]
    v_mfma_f32_16x16x32_bf16 v[72:75], a[12:15], v[152:155], v[72:75]
    buffer_load_dwordx4 v[196:199], v3, s[40:43], s27 offen sc1
    v_mfma_f32_16x16x32_bf16 v[76:79], a[12:15], a[200:203], v[76:79]
    v_mfma_f32_16x16x32_bf16 v[80:83], a[16:19], v[144:147], v[80:83]
    v_mfma_f32_16x16x32_bf16 v[84:87], a[16:19], v[148:151], v[84:87]
    v_mfma_f32_16x16x32_bf16 v[88:91], a[16:19], v[152:155], v[88:91]
    buffer_load_dwordx4 v[200:203], v4, s[40:43], s27 offen sc1
    v_mfma_f32_16x16x32_bf16 v[92:95], a[16:19], a[200:203], v[92:95]
    s_waitcnt vmcnt(27)
    v_mfma_f32_16x16x32_bf16 v[16:19], a[20:23], a[204:207], v[16:19]
    s_waitcnt vmcnt(26)
    v_mfma_f32_16x16x32_bf16 v[20:23], a[20:23], a[208:211], v[20:23]
    s_mul_i32 s26, s52, 5120
    s_add_u32 s26, s26, s24
    buffer_load_dwordx4 v[204:207], v14, s[40:43], s26 offen offset:0 sc1
    s_waitcnt vmcnt(26)
    v_mfma_f32_16x16x32_bf16 v[24:27], a[20:23], a[212:215], v[24:27]
    s_waitcnt vmcnt(25)
    v_mfma_f32_16x16x32_bf16 v[28:31], a[20:23], a[216:219], v[28:31]
    v_mfma_f32_16x16x32_bf16 v[32:35], a[24:27], a[204:207], v[32:35]
    v_mfma_f32_16x16x32_bf16 v[36:39], a[24:27], a[208:211], v[36:39]
    buffer_load_dwordx4 v[208:211], v14, s[40:43], s26 offen offset:1024 sc1
    v_mfma_f32_16x16x32_bf16 v[40:43], a[24:27], a[212:215], v[40:43]
    v_mfma_f32_16x16x32_bf16 v[44:47], a[24:27], a[216:219], v[44:47]
    v_mfma_f32_16x16x32_bf16 v[48:51], a[28:31], a[204:207], v[48:51]
    buffer_load_dwordx4 v[212:215], v14, s[40:43], s26 offen offset:2048 sc1
    v_mfma_f32_16x16x32_bf16 v[52:55], a[28:31], a[208:211], v[52:55]
    v_mfma_f32_16x16x32_bf16 v[56:59], a[28:31], a[212:215], v[56:59]
    v_mfma_f32_16x16x32_bf16 v[60:63], a[28:31], a[216:219], v[60:63]
    v_mfma_f32_16x16x32_bf16 v[64:67], a[32:35], a[204:207], v[64:67]
    buffer_load_dwordx4 a[172:175], v14, s[40:43], s26 offen offset:3072 sc1
    v_mfma_f32_16x16x32_bf16 v[68:71], a[32:35], a[208:211], v[68:71]
    v_mfma_f32_16x16x32_bf16 v[72:75], a[32:35], a[212:215], v[72:75]
    v_mfma_f32_16x16x32_bf16 v[76:79], a[32:35], a[216:219], v[76:79]
    buffer_load_dwordx4 a[176:179], v15, s[40:43], s26 offen sc1
    v_mfma_f32_16x16x32_bf16 v[80:83], a[36:39], a[204:207], v[80:83]
    v_mfma_f32_16x16x32_bf16 v[84:87], a[36:39], a[208:211], v[84:87]
    v_mfma_f32_16x16x32_bf16 v[88:91], a[36:39], a[212:215], v[88:91]
    v_mfma_f32_16x16x32_bf16 v[92:95], a[36:39], a[216:219], v[92:95]
    s_lshl_b32 s27, s52, 12
    s_add_u32 s27, s27, s25
    buffer_load_dwordx4 v[124:127], v1, s[40:43], s27 offen sc1
    s_waitcnt vmcnt(29)
    v_mfma_f32_16x16x32_bf16 v[16:19], a[40:43], v[156:159], v[16:19]
    s_waitcnt vmcnt(28)
    v_mfma_f32_16x16x32_bf16 v[20:23], a[40:43], v[160:163], v[20:23]
    v_lshlrev_b32 v96, 16, v100
    s_waitcnt vmcnt(27)
    v_mfma_f32_16x16x32_bf16 v[24:27], a[40:43], v[164:167], v[24:27]
    buffer_load_dwordx4 v[128:131], v2, s[40:43], s27 offen sc1
    s_waitcnt vmcnt(27)
    v_mfma_f32_16x16x32_bf16 v[28:31], a[40:43], v[168:171], v[28:31]
    v_lshlrev_b32 v97, 16, v110
    v_mfma_f32_16x16x32_bf16 v[32:35], a[44:47], v[156:159], v[32:35]
    v_mfma_f32_16x16x32_bf16 v[36:39], a[44:47], v[160:163], v[36:39]
    v_and_b32 v100, 0xffff0000, v100
    v_mfma_f32_16x16x32_bf16 v[40:43], a[44:47], v[164:167], v[40:43]
    buffer_load_dwordx4 v[216:219], v3, s[40:43], s27 offen sc1
    v_mfma_f32_16x16x32_bf16 v[44:47], a[44:47], v[168:171], v[44:47]
    v_and_b32 v110, 0xffff0000, v110
    v_mfma_f32_16x16x32_bf16 v[48:51], a[48:51], v[156:159], v[48:51]
    v_mfma_f32_16x16x32_bf16 v[52:55], a[48:51], v[160:163], v[52:55]
    buffer_load_dwordx4 v[220:223], v4, s[40:43], s27 offen sc1
    v_mfma_f32_16x16x32_bf16 v[56:59], a[48:51], v[164:167], v[56:59]
    v_mfma_f32_16x16x32_bf16 v[60:63], a[48:51], v[168:171], v[60:63]
    v_mul_f32 v100, v100, v110
    v_mfma_f32_16x16x32_bf16 v[64:67], a[52:55], v[156:159], v[64:67]
    v_mfma_f32_16x16x32_bf16 v[68:71], a[52:55], v[160:163], v[68:71]
    s_mul_i32 s26, s53, 5120
    s_add_u32 s26, s26, s24
    buffer_load_dwordx4 v[224:227], v14, s[40:43], s26 offen offset:0 sc1
    v_mfma_f32_16x16x32_bf16 v[72:75], a[52:55], v[164:167], v[72:75]
    v_mfma_f32_16x16x32_bf16 v[76:79], a[52:55], v[168:171], v[76:79]
    v_mul_f32 v110, v96, v97
    v_mfma_f32_16x16x32_bf16 v[80:83], a[56:59], v[156:159], v[80:83]
    buffer_load_dwordx4 v[228:231], v14, s[40:43], s26 offen offset:1024 sc1
    v_mfma_f32_16x16x32_bf16 v[84:87], a[56:59], v[160:163], v[84:87]
    v_lshlrev_b32 v96, 16, v101
    v_mfma_f32_16x16x32_bf16 v[88:91], a[56:59], v[164:167], v[88:91]
    v_mfma_f32_16x16x32_bf16 v[92:95], a[56:59], v[168:171], v[92:95]
    v_lshlrev_b32 v97, 16, v111
    s_waitcnt vmcnt(30)
    v_mfma_f32_16x16x32_bf16 v[16:19], a[60:63], a[220:223], v[16:19]
    buffer_load_dwordx4 v[232:235], v14, s[40:43], s26 offen offset:2048 sc1
    s_waitcnt vmcnt(30)
    v_mfma_f32_16x16x32_bf16 v[20:23], a[60:63], a[224:227], v[20:23]
    v_and_b32 v101, 0xffff0000, v101
    s_waitcnt vmcnt(29)
    v_mfma_f32_16x16x32_bf16 v[24:27], a[60:63], a[228:231], v[24:27]
    s_waitcnt vmcnt(28)
    v_mfma_f32_16x16x32_bf16 v[28:31], a[60:63], a[232:235], v[28:31]
    buffer_load_dwordx4 v[132:135], v14, s[40:43], s26 offen offset:3072 sc1
    v_mfma_f32_16x16x32_bf16 v[32:35], a[64:67], a[220:223], v[32:35]
    v_mfma_f32_16x16x32_bf16 v[36:39], a[64:67], a[224:227], v[36:39]
    v_and_b32 v111, 0xffff0000, v111
    v_mfma_f32_16x16x32_bf16 v[40:43], a[64:67], a[228:231], v[40:43]
    v_mfma_f32_16x16x32_bf16 v[44:47], a[64:67], a[232:235], v[44:47]
    buffer_load_dwordx4 v[136:139], v15, s[40:43], s26 offen sc1
    v_mfma_f32_16x16x32_bf16 v[48:51], a[68:71], a[220:223], v[48:51]
    v_mfma_f32_16x16x32_bf16 v[52:55], a[68:71], a[224:227], v[52:55]
    v_mul_f32 v101, v101, v111
    v_mfma_f32_16x16x32_bf16 v[56:59], a[68:71], a[228:231], v[56:59]
    s_lshl_b32 s27, s53, 12
    s_add_u32 s27, s27, s25
    buffer_load_dwordx4 a[180:183], v1, s[40:43], s27 offen sc1
    v_mfma_f32_16x16x32_bf16 v[60:63], a[68:71], a[232:235], v[60:63]
    v_mul_f32 v111, v96, v97
    v_mfma_f32_16x16x32_bf16 v[64:67], a[72:75], a[220:223], v[64:67]
    v_mfma_f32_16x16x32_bf16 v[68:71], a[72:75], a[224:227], v[68:71]
    v_lshlrev_b32 v96, 16, v102
    v_mfma_f32_16x16x32_bf16 v[72:75], a[72:75], a[228:231], v[72:75]
    buffer_load_dwordx4 a[184:187], v2, s[40:43], s27 offen sc1
    v_mfma_f32_16x16x32_bf16 v[76:79], a[72:75], a[232:235], v[76:79]
    v_lshlrev_b32 v97, 16, v112
    v_mfma_f32_16x16x32_bf16 v[80:83], a[76:79], a[220:223], v[80:83]
    v_mfma_f32_16x16x32_bf16 v[84:87], a[76:79], a[224:227], v[84:87]
    buffer_load_dwordx4 v[236:239], v3, s[40:43], s27 offen sc1
    v_mfma_f32_16x16x32_bf16 v[88:91], a[76:79], a[228:231], v[88:91]
    v_mfma_f32_16x16x32_bf16 v[92:95], a[76:79], a[232:235], v[92:95]
    v_and_b32 v102, 0xffff0000, v102
    s_waitcnt vmcnt(32)
    v_mfma_f32_16x16x32_bf16 v[16:19], a[80:83], a[236:239], v[16:19]
    s_waitcnt vmcnt(31)
    v_mfma_f32_16x16x32_bf16 v[20:23], a[80:83], v[172:175], v[20:23]
    buffer_load_dwordx4 v[240:243], v4, s[40:43], s27 offen sc1
    s_waitcnt vmcnt(31)
    v_mfma_f32_16x16x32_bf16 v[24:27], a[80:83], v[176:179], v[24:27]
    s_waitcnt vmcnt(30)
    v_mfma_f32_16x16x32_bf16 v[28:31], a[80:83], v[180:183], v[28:31]
    v_and_b32 v112, 0xffff0000, v112
    v_mfma_f32_16x16x32_bf16 v[32:35], a[84:87], a[236:239], v[32:35]
    s_mul_i32 s26, s54, 5120
    s_add_u32 s26, s26, s24
    buffer_load_dwordx4 v[244:247], v14, s[40:43], s26 offen offset:0 sc1
    v_mfma_f32_16x16x32_bf16 v[36:39], a[84:87], v[172:175], v[36:39]
    v_mul_f32 v102, v102, v112
    v_mfma_f32_16x16x32_bf16 v[40:43], a[84:87], v[176:179], v[40:43]
    v_mfma_f32_16x16x32_bf16 v[44:47], a[84:87], v[180:183], v[44:47]
    v_mul_f32 v112, v96, v97
    v_mfma_f32_16x16x32_bf16 v[48:51], a[88:91], a[236:239], v[48:51]
    buffer_load_dwordx4 v[248:251], v14, s[40:43], s26 offen offset:1024 sc1
    v_mfma_f32_16x16x32_bf16 v[52:55], a[88:91], v[172:175], v[52:55]
    v_lshlrev_b32 v96, 16, v103
    v_mfma_f32_16x16x32_bf16 v[56:59], a[88:91], v[176:179], v[56:59]
    v_mfma_f32_16x16x32_bf16 v[60:63], a[88:91], v[180:183], v[60:63]
    buffer_load_dwordx4 v[252:255], v14, s[40:43], s26 offen offset:2048 sc1
    v_mfma_f32_16x16x32_bf16 v[64:67], a[92:95], a[236:239], v[64:67]
    v_mfma_f32_16x16x32_bf16 v[68:71], a[92:95], v[172:175], v[68:71]
    v_lshlrev_b32 v97, 16, v113
    v_mfma_f32_16x16x32_bf16 v[72:75], a[92:95], v[176:179], v[72:75]
    v_mfma_f32_16x16x32_bf16 v[76:79], a[92:95], v[180:183], v[76:79]
    buffer_load_dwordx4 a[188:191], v14, s[40:43], s26 offen offset:3072 sc1
    v_mfma_f32_16x16x32_bf16 v[80:83], a[96:99], a[236:239], v[80:83]
    v_mfma_f32_16x16x32_bf16 v[84:87], a[96:99], v[172:175], v[84:87]
    v_and_b32 v103, 0xffff0000, v103
    v_mfma_f32_16x16x32_bf16 v[88:91], a[96:99], v[176:179], v[88:91]
    buffer_load_dwordx4 a[192:195], v15, s[40:43], s26 offen sc1
    v_mfma_f32_16x16x32_bf16 v[92:95], a[96:99], v[180:183], v[92:95]
    v_and_b32 v113, 0xffff0000, v113
    s_waitcnt vmcnt(34)
    v_mfma_f32_16x16x32_bf16 v[16:19], a[100:103], v[184:187], v[16:19]
    s_waitcnt vmcnt(33)
    v_mfma_f32_16x16x32_bf16 v[20:23], a[100:103], a[240:243], v[20:23]
    v_mul_f32 v103, v103, v113
    s_waitcnt vmcnt(32)
    v_mfma_f32_16x16x32_bf16 v[24:27], a[100:103], a[244:247], v[24:27]
    s_lshl_b32 s27, s54, 12
    s_add_u32 s27, s27, s25
    buffer_load_dwordx4 a[196:199], v1, s[40:43], s27 offen sc1
    s_waitcnt vmcnt(32)
    v_mfma_f32_16x16x32_bf16 v[28:31], a[100:103], a[248:251], v[28:31]
    v_mul_f32 v113, v96, v97
    v_mfma_f32_16x16x32_bf16 v[32:35], a[104:107], v[184:187], v[32:35]
    v_mfma_f32_16x16x32_bf16 v[36:39], a[104:107], a[240:243], v[36:39]
    buffer_load_dwordx4 v[140:143], v2, s[40:43], s27 offen sc1
    v_mfma_f32_16x16x32_bf16 v[40:43], a[104:107], a[244:247], v[40:43]
    v_mfma_f32_16x16x32_bf16 v[44:47], a[104:107], a[248:251], v[44:47]
    v_lshlrev_b32 v96, 16, v104
    v_mfma_f32_16x16x32_bf16 v[48:51], a[108:111], v[184:187], v[48:51]
    v_mfma_f32_16x16x32_bf16 v[52:55], a[108:111], a[240:243], v[52:55]
    buffer_load_dwordx4 a[0:3], v3, s[40:43], s27 offen sc1
    v_mfma_f32_16x16x32_bf16 v[56:59], a[108:111], a[244:247], v[56:59]
    v_mfma_f32_16x16x32_bf16 v[60:63], a[108:111], a[248:251], v[60:63]
    v_lshlrev_b32 v97, 16, v114
    v_mfma_f32_16x16x32_bf16 v[64:67], a[112:115], v[184:187], v[64:67]
    buffer_load_dwordx4 a[4:7], v4, s[40:43], s27 offen sc1
    v_mfma_f32_16x16x32_bf16 v[68:71], a[112:115], a[240:243], v[68:71]
    v_and_b32 v104, 0xffff0000, v104
    v_mfma_f32_16x16x32_bf16 v[72:75], a[112:115], a[244:247], v[72:75]
    v_mfma_f32_16x16x32_bf16 v[76:79], a[112:115], a[248:251], v[76:79]
    v_and_b32 v114, 0xffff0000, v114
    v_mfma_f32_16x16x32_bf16 v[80:83], a[116:119], v[184:187], v[80:83]
    s_mul_i32 s26, s55, 5120
    s_add_u32 s26, s26, s24
    buffer_load_dwordx4 a[8:11], v14, s[40:43], s26 offen offset:0 sc1
    v_mfma_f32_16x16x32_bf16 v[84:87], a[116:119], a[240:243], v[84:87]
    v_mul_f32 v104, v104, v114
    v_mfma_f32_16x16x32_bf16 v[88:91], a[116:119], a[244:247], v[88:91]
    v_mfma_f32_16x16x32_bf16 v[92:95], a[116:119], a[248:251], v[92:95]
    buffer_load_dwordx4 a[12:15], v14, s[40:43], s26 offen offset:1024 sc1
    s_waitcnt vmcnt(36)
    v_mfma_f32_16x16x32_bf16 v[16:19], a[120:123], a[252:255], v[16:19]
    s_waitcnt vmcnt(35)
    v_mfma_f32_16x16x32_bf16 v[20:23], a[120:123], v[192:195], v[20:23]
    v_mul_f32 v114, v96, v97
    s_waitcnt vmcnt(34)
    v_mfma_f32_16x16x32_bf16 v[24:27], a[120:123], v[188:191], v[24:27]
    s_waitcnt vmcnt(33)
    v_mfma_f32_16x16x32_bf16 v[28:31], a[120:123], a[160:163], v[28:31]
    buffer_load_dwordx4 a[16:19], v14, s[40:43], s26 offen offset:2048 sc1
    v_mfma_f32_16x16x32_bf16 v[32:35], a[124:127], a[252:255], v[32:35]
    v_mfma_f32_16x16x32_bf16 v[36:39], a[124:127], v[192:195], v[36:39]
    v_lshlrev_b32 v96, 16, v105
    v_mfma_f32_16x16x32_bf16 v[40:43], a[124:127], v[188:191], v[40:43]
    buffer_load_dwordx4 v[144:147], v14, s[40:43], s26 offen offset:3072 sc1
    v_mfma_f32_16x16x32_bf16 v[44:47], a[124:127], a[160:163], v[44:47]
    v_lshlrev_b32 v97, 16, v115
    v_mfma_f32_16x16x32_bf16 v[48:51], a[128:131], a[252:255], v[48:51]
    v_mfma_f32_16x16x32_bf16 v[52:55], a[128:131], v[192:195], v[52:55]
    v_and_b32 v105, 0xffff0000, v105
    v_mfma_f32_16x16x32_bf16 v[56:59], a[128:131], v[188:191], v[56:59]
    buffer_load_dwordx4 v[148:151], v15, s[40:43], s26 offen sc1
    v_mfma_f32_16x16x32_bf16 v[60:63], a[128:131], a[160:163], v[60:63]
    v_and_b32 v115, 0xffff0000, v115
    v_mfma_f32_16x16x32_bf16 v[64:67], a[132:135], a[252:255], v[64:67]
    v_mfma_f32_16x16x32_bf16 v[68:71], a[132:135], v[192:195], v[68:71]
    s_lshl_b32 s27, s55, 12
    s_add_u32 s27, s27, s25
    buffer_load_dwordx4 v[152:155], v1, s[40:43], s27 offen sc1
    v_mfma_f32_16x16x32_bf16 v[72:75], a[132:135], v[188:191], v[72:75]
    v_mfma_f32_16x16x32_bf16 v[76:79], a[132:135], a[160:163], v[76:79]
    v_mul_f32 v105, v105, v115
    v_mfma_f32_16x16x32_bf16 v[80:83], a[136:139], a[252:255], v[80:83]
    v_mfma_f32_16x16x32_bf16 v[84:87], a[136:139], v[192:195], v[84:87]
    buffer_load_dwordx4 a[200:203], v2, s[40:43], s27 offen sc1
    v_mfma_f32_16x16x32_bf16 v[88:91], a[136:139], v[188:191], v[88:91]
    v_mfma_f32_16x16x32_bf16 v[92:95], a[136:139], a[160:163], v[92:95]
    v_mul_f32 v115, v96, v97
    s_waitcnt vmcnt(37)
    v_mfma_f32_16x16x32_bf16 v[16:19], a[140:143], a[164:167], v[16:19]
    buffer_load_dwordx4 a[20:23], v3, s[40:43], s27 offen sc1
    s_waitcnt vmcnt(37)
    v_mfma_f32_16x16x32_bf16 v[20:23], a[140:143], a[168:171], v[20:23]
    v_lshlrev_b32 v96, 16, v106
    s_waitcnt vmcnt(36)
    v_mfma_f32_16x16x32_bf16 v[24:27], a[140:143], v[196:199], v[24:27]
    s_waitcnt vmcnt(35)
    v_mfma_f32_16x16x32_bf16 v[28:31], a[140:143], v[200:203], v[28:31]
    v_lshlrev_b32 v97, 16, v116
    v_mfma_f32_16x16x32_bf16 v[32:35], a[144:147], a[164:167], v[32:35]
    buffer_load_dwordx4 a[24:27], v4, s[40:43], s27 offen sc1
    v_mfma_f32_16x16x32_bf16 v[36:39], a[144:147], a[168:171], v[36:39]
    v_and_b32 v106, 0xffff0000, v106
    v_mfma_f32_16x16x32_bf16 v[40:43], a[144:147], v[196:199], v[40:43]
    v_mfma_f32_16x16x32_bf16 v[44:47], a[144:147], v[200:203], v[44:47]
    s_mul_i32 s26, s56, 5120
    s_add_u32 s26, s26, s24
    buffer_load_dwordx4 a[28:31], v14, s[40:43], s26 offen offset:0 sc1
    v_mfma_f32_16x16x32_bf16 v[48:51], a[148:151], a[164:167], v[48:51]
    v_mfma_f32_16x16x32_bf16 v[52:55], a[148:151], a[168:171], v[52:55]
    v_and_b32 v116, 0xffff0000, v116
    v_mfma_f32_16x16x32_bf16 v[56:59], a[148:151], v[196:199], v[56:59]
    v_mfma_f32_16x16x32_bf16 v[60:63], a[148:151], v[200:203], v[60:63]
    buffer_load_dwordx4 a[32:35], v14, s[40:43], s26 offen offset:1024 sc1
    v_mfma_f32_16x16x32_bf16 v[64:67], a[152:155], a[164:167], v[64:67]
    v_mfma_f32_16x16x32_bf16 v[68:71], a[152:155], a[168:171], v[68:71]
    v_mul_f32 v106, v106, v116
    v_mfma_f32_16x16x32_bf16 v[72:75], a[152:155], v[196:199], v[72:75]
    buffer_load_dwordx4 a[36:39], v14, s[40:43], s26 offen offset:2048 sc1
    v_mfma_f32_16x16x32_bf16 v[76:79], a[152:155], v[200:203], v[76:79]
    v_mul_f32 v116, v96, v97
    v_mfma_f32_16x16x32_bf16 v[80:83], a[156:159], a[164:167], v[80:83]
    v_mfma_f32_16x16x32_bf16 v[84:87], a[156:159], a[168:171], v[84:87]
    v_lshlrev_b32 v96, 16, v107
    v_mfma_f32_16x16x32_bf16 v[88:91], a[156:159], v[196:199], v[88:91]
    buffer_load_dwordx4 a[204:207], v14, s[40:43], s26 offen offset:3072 sc1
    v_mfma_f32_16x16x32_bf16 v[92:95], a[156:159], v[200:203], v[92:95]
    v_lshlrev_b32 v97, 16, v117
    s_waitcnt vmcnt(34)
    v_mfma_f32_16x16x32_bf16 v[16:19], v[204:207], v[124:127], v[16:19]
    s_waitcnt vmcnt(33)
    v_mfma_f32_16x16x32_bf16 v[20:23], v[204:207], v[128:131], v[20:23]
    buffer_load_dwordx4 a[208:211], v15, s[40:43], s26 offen sc1
    s_waitcnt vmcnt(33)
    v_mfma_f32_16x16x32_bf16 v[24:27], v[204:207], v[216:219], v[24:27]
    s_waitcnt vmcnt(32)
    v_mfma_f32_16x16x32_bf16 v[28:31], v[204:207], v[220:223], v[28:31]
    v_and_b32 v107, 0xffff0000, v107
    v_mfma_f32_16x16x32_bf16 v[32:35], v[208:211], v[124:127], v[32:35]
    v_mfma_f32_16x16x32_bf16 v[36:39], v[208:211], v[128:131], v[36:39]
    s_lshl_b32 s27, s56, 12
    s_add_u32 s27, s27, s25
    buffer_load_dwordx4 a[212:215], v1, s[40:43], s27 offen sc1
    v_mfma_f32_16x16x32_bf16 v[40:43], v[208:211], v[216:219], v[40:43]
    v_mfma_f32_16x16x32_bf16 v[44:47], v[208:211], v[220:223], v[44:47]
    v_and_b32 v117, 0xffff0000, v117
    v_mfma_f32_16x16x32_bf16 v[48:51], v[212:215], v[124:127], v[48:51]
    buffer_load_dwordx4 a[216:219], v2, s[40:43], s27 offen sc1
    v_mfma_f32_16x16x32_bf16 v[52:55], v[212:215], v[128:131], v[52:55]
    v_mul_f32 v107, v107, v117
    v_mfma_f32_16x16x32_bf16 v[56:59], v[212:215], v[216:219], v[56:59]
    v_mfma_f32_16x16x32_bf16 v[60:63], v[212:215], v[220:223], v[60:63]
    v_mul_f32 v117, v96, v97
    v_mfma_f32_16x16x32_bf16 v[64:67], a[172:175], v[124:127], v[64:67]
    buffer_load_dwordx4 a[40:43], v3, s[40:43], s27 offen sc1
    v_mfma_f32_16x16x32_bf16 v[68:71], a[172:175], v[128:131], v[68:71]
    v_lshlrev_b32 v96, 16, v108
    v_mfma_f32_16x16x32_bf16 v[72:75], a[172:175], v[216:219], v[72:75]
    v_mfma_f32_16x16x32_bf16 v[76:79], a[172:175], v[220:223], v[76:79]
    buffer_load_dwordx4 a[44:47], v4, s[40:43], s27 offen sc1
    v_mfma_f32_16x16x32_bf16 v[80:83], a[176:179], v[124:127], v[80:83]
    v_mfma_f32_16x16x32_bf16 v[84:87], a[176:179], v[128:131], v[84:87]
    v_lshlrev_b32 v97, 16, v118
    v_mfma_f32_16x16x32_bf16 v[88:91], a[176:179], v[216:219], v[88:91]
    v_mfma_f32_16x16x32_bf16 v[92:95], a[176:179], v[220:223], v[92:95]
    s_mul_i32 s26, s57, 5120
    s_add_u32 s26, s26, s24
    buffer_load_dwordx4 a[48:51], v14, s[40:43], s26 offen offset:0 sc1
    s_waitcnt vmcnt(31)
    v_mfma_f32_16x16x32_bf16 v[16:19], v[224:227], a[180:183], v[16:19]
    s_waitcnt vmcnt(30)
    v_mfma_f32_16x16x32_bf16 v[20:23], v[224:227], a[184:187], v[20:23]
    v_and_b32 v108, 0xffff0000, v108
    s_waitcnt vmcnt(29)
    v_mfma_f32_16x16x32_bf16 v[24:27], v[224:227], v[236:239], v[24:27]
    buffer_load_dwordx4 a[52:55], v14, s[40:43], s26 offen offset:1024 sc1
    s_waitcnt vmcnt(29)
    v_mfma_f32_16x16x32_bf16 v[28:31], v[224:227], v[240:243], v[28:31]
    v_and_b32 v118, 0xffff0000, v118
    v_mfma_f32_16x16x32_bf16 v[32:35], v[228:231], a[180:183], v[32:35]
    v_mfma_f32_16x16x32_bf16 v[36:39], v[228:231], a[184:187], v[36:39]
    v_mul_f32 v108, v108, v118
    v_mfma_f32_16x16x32_bf16 v[40:43], v[228:231], v[236:239], v[40:43]
    buffer_load_dwordx4 a[56:59], v14, s[40:43], s26 offen offset:2048 sc1
    v_mfma_f32_16x16x32_bf16 v[44:47], v[228:231], v[240:243], v[44:47]
    v_mul_f32 v118, v96, v97
    v_mfma_f32_16x16x32_bf16 v[48:51], v[232:235], a[180:183], v[48:51]
    v_mfma_f32_16x16x32_bf16 v[52:55], v[232:235], a[184:187], v[52:55]
    buffer_load_dwordx4 v[156:159], v14, s[40:43], s26 offen offset:3072 sc1
    v_mfma_f32_16x16x32_bf16 v[56:59], v[232:235], v[236:239], v[56:59]
    v_mfma_f32_16x16x32_bf16 v[60:63], v[232:235], v[240:243], v[60:63]
    v_lshlrev_b32 v96, 16, v109
    v_mfma_f32_16x16x32_bf16 v[64:67], v[132:135], a[180:183], v[64:67]
    v_mfma_f32_16x16x32_bf16 v[68:71], v[132:135], a[184:187], v[68:71]
    buffer_load_dwordx4 v[160:163], v15, s[40:43], s26 offen sc1
    v_mfma_f32_16x16x32_bf16 v[72:75], v[132:135], v[236:239], v[72:75]
    v_mfma_f32_16x16x32_bf16 v[76:79], v[132:135], v[240:243], v[76:79]
    v_lshlrev_b32 v97, 16, v119
    v_mfma_f32_16x16x32_bf16 v[80:83], v[136:139], a[180:183], v[80:83]
    s_lshl_b32 s27, s57, 12
    s_add_u32 s27, s27, s25
    buffer_load_dwordx4 v[164:167], v1, s[40:43], s27 offen sc1
    v_mfma_f32_16x16x32_bf16 v[84:87], v[136:139], a[184:187], v[84:87]
    v_and_b32 v109, 0xffff0000, v109
    v_mfma_f32_16x16x32_bf16 v[88:91], v[136:139], v[236:239], v[88:91]
    v_mfma_f32_16x16x32_bf16 v[92:95], v[136:139], v[240:243], v[92:95]
    v_and_b32 v119, 0xffff0000, v119
    s_waitcnt vmcnt(27)
    v_mfma_f32_16x16x32_bf16 v[16:19], v[244:247], a[196:199], v[16:19]
    buffer_load_dwordx4 v[168:171], v2, s[40:43], s27 offen sc1
    s_waitcnt vmcnt(27)
    v_mfma_f32_16x16x32_bf16 v[20:23], v[244:247], v[140:143], v[20:23]
    v_mul_f32 v109, v109, v119
    s_waitcnt vmcnt(26)
    v_mfma_f32_16x16x32_bf16 v[24:27], v[244:247], a[0:3], v[24:27]
    s_waitcnt vmcnt(25)
    v_mfma_f32_16x16x32_bf16 v[28:31], v[244:247], a[4:7], v[28:31]
    buffer_load_dwordx4 a[60:63], v3, s[40:43], s27 offen sc1
    v_mfma_f32_16x16x32_bf16 v[32:35], v[248:251], a[196:199], v[32:35]
    v_mfma_f32_16x16x32_bf16 v[36:39], v[248:251], v[140:143], v[36:39]
    v_mul_f32 v119, v96, v97
    v_mfma_f32_16x16x32_bf16 v[40:43], v[248:251], a[0:3], v[40:43]
    v_mfma_f32_16x16x32_bf16 v[44:47], v[248:251], a[4:7], v[44:47]
    buffer_load_dwordx4 a[64:67], v4, s[40:43], s27 offen sc1
    v_mfma_f32_16x16x32_bf16 v[48:51], v[252:255], a[196:199], v[48:51]
    v_mfma_f32_16x16x32_bf16 v[52:55], v[252:255], v[140:143], v[52:55]
    v_mfma_f32_16x16x32_bf16 v[56:59], v[252:255], a[0:3], v[56:59]
    v_mfma_f32_16x16x32_bf16 v[60:63], v[252:255], a[4:7], v[60:63]
    v_mfma_f32_16x16x32_bf16 v[64:67], a[188:191], a[196:199], v[64:67]
    v_mfma_f32_16x16x32_bf16 v[68:71], a[188:191], v[140:143], v[68:71]
    v_mfma_f32_16x16x32_bf16 v[72:75], a[188:191], a[0:3], v[72:75]
    v_mfma_f32_16x16x32_bf16 v[76:79], a[188:191], a[4:7], v[76:79]
    v_mfma_f32_16x16x32_bf16 v[80:83], a[192:195], a[196:199], v[80:83]
    v_mfma_f32_16x16x32_bf16 v[84:87], a[192:195], v[140:143], v[84:87]
    v_mfma_f32_16x16x32_bf16 v[88:91], a[192:195], a[0:3], v[88:91]
    v_mfma_f32_16x16x32_bf16 v[92:95], a[192:195], a[4:7], v[92:95]
    s_waitcnt vmcnt(20)
    v_mfma_f32_16x16x32_bf16 v[20:23], a[8:11], a[200:203], v[20:23]
    s_waitcnt vmcnt(11)
    v_mfma_f32_16x16x32_bf16 v[20:23], a[28:31], a[216:219], v[20:23]
    s_waitcnt vmcnt(2)
    v_mfma_f32_16x16x32_bf16 v[20:23], a[48:51], v[168:171], v[20:23]
    v_mfma_f32_16x16x32_bf16 v[36:39], a[12:15], a[200:203], v[36:39]
    v_mfma_f32_16x16x32_bf16 v[36:39], a[32:35], a[216:219], v[36:39]
    v_mfma_f32_16x16x32_bf16 v[36:39], a[52:55], v[168:171], v[36:39]
    v_mfma_f32_16x16x32_bf16 v[52:55], a[16:19], a[200:203], v[52:55]
    v_mfma_f32_16x16x32_bf16 v[52:55], a[36:39], a[216:219], v[52:55]
    v_mfma_f32_16x16x32_bf16 v[52:55], a[56:59], v[168:171], v[52:55]
    s_nop 1
    ds_write_b128 v5, v[20:23] offset:0
    v_mfma_f32_16x16x32_bf16 v[68:71], v[144:147], a[200:203], v[68:71]
    v_mfma_f32_16x16x32_bf16 v[68:71], a[204:207], a[216:219], v[68:71]
    v_mfma_f32_16x16x32_bf16 v[68:71], v[156:159], v[168:171], v[68:71]
    ds_write_b128 v5, v[36:39] offset:1024
    v_mfma_f32_16x16x32_bf16 v[84:87], v[148:151], a[200:203], v[84:87]
    v_mfma_f32_16x16x32_bf16 v[84:87], a[208:211], a[216:219], v[84:87]
    v_mfma_f32_16x16x32_bf16 v[84:87], v[160:163], v[168:171], v[84:87]
    ds_write_b128 v5, v[52:55] offset:2048
    v_mfma_f32_16x16x32_bf16 v[24:27], a[8:11], a[20:23], v[24:27]
    v_mfma_f32_16x16x32_bf16 v[24:27], a[28:31], a[40:43], v[24:27]
    s_waitcnt vmcnt(1)
    v_mfma_f32_16x16x32_bf16 v[24:27], a[48:51], a[60:63], v[24:27]
    ds_write_b128 v5, v[68:71] offset:3072
    v_mfma_f32_16x16x32_bf16 v[40:43], a[12:15], a[20:23], v[40:43]
    v_mfma_f32_16x16x32_bf16 v[40:43], a[32:35], a[40:43], v[40:43]
    v_mfma_f32_16x16x32_bf16 v[40:43], a[52:55], a[60:63], v[40:43]
    ds_write_b128 v5, v[84:87] offset:4096
    v_mfma_f32_16x16x32_bf16 v[56:59], a[16:19], a[20:23], v[56:59]
    v_mfma_f32_16x16x32_bf16 v[56:59], a[36:39], a[40:43], v[56:59]
    v_mfma_f32_16x16x32_bf16 v[56:59], a[56:59], a[60:63], v[56:59]
    ds_write_b128 v6, v[24:27] offset:0
    v_mfma_f32_16x16x32_bf16 v[72:75], v[144:147], a[20:23], v[72:75]
    v_mfma_f32_16x16x32_bf16 v[72:75], a[204:207], a[40:43], v[72:75]
    v_mfma_f32_16x16x32_bf16 v[72:75], v[156:159], a[60:63], v[72:75]
    ds_write_b128 v6, v[40:43] offset:1024
    v_mfma_f32_16x16x32_bf16 v[88:91], v[148:151], a[20:23], v[88:91]
    v_mfma_f32_16x16x32_bf16 v[88:91], a[208:211], a[40:43], v[88:91]
    v_mfma_f32_16x16x32_bf16 v[88:91], v[160:163], a[60:63], v[88:91]
    ds_write_b128 v6, v[56:59] offset:2048
    v_mfma_f32_16x16x32_bf16 v[28:31], a[8:11], a[24:27], v[28:31]
    v_mfma_f32_16x16x32_bf16 v[28:31], a[28:31], a[44:47], v[28:31]
    s_waitcnt vmcnt(0)
    v_mfma_f32_16x16x32_bf16 v[28:31], a[48:51], a[64:67], v[28:31]
    ds_write_b128 v6, v[72:75] offset:3072
    v_mfma_f32_16x16x32_bf16 v[44:47], a[12:15], a[24:27], v[44:47]
    v_mfma_f32_16x16x32_bf16 v[44:47], a[32:35], a[44:47], v[44:47]
    v_mfma_f32_16x16x32_bf16 v[44:47], a[52:55], a[64:67], v[44:47]
    ds_write_b128 v6, v[88:91] offset:4096
    v_mfma_f32_16x16x32_bf16 v[60:63], a[16:19], a[24:27], v[60:63]
    v_mfma_f32_16x16x32_bf16 v[60:63], a[36:39], a[44:47], v[60:63]
    v_mfma_f32_16x16x32_bf16 v[60:63], a[56:59], a[64:67], v[60:63]
    ds_write_b128 v7, v[28:31] offset:0
    v_mfma_f32_16x16x32_bf16 v[76:79], v[144:147], a[24:27], v[76:79]
    v_mfma_f32_16x16x32_bf16 v[76:79], a[204:207], a[44:47], v[76:79]
    v_mfma_f32_16x16x32_bf16 v[76:79], v[156:159], a[64:67], v[76:79]
    ds_write_b128 v7, v[44:47] offset:1024
    v_mfma_f32_16x16x32_bf16 v[92:95], v[148:151], a[24:27], v[92:95]
    v_mfma_f32_16x16x32_bf16 v[92:95], a[208:211], a[44:47], v[92:95]
    v_mfma_f32_16x16x32_bf16 v[92:95], v[160:163], a[64:67], v[92:95]
    ds_write_b128 v7, v[60:63] offset:2048
    v_mfma_f32_16x16x32_bf16 v[16:19], a[8:11], v[152:155], v[16:19]
    v_mfma_f32_16x16x32_bf16 v[16:19], a[28:31], a[212:215], v[16:19]
    v_mfma_f32_16x16x32_bf16 v[16:19], a[48:51], v[164:167], v[16:19]
    ds_write_b128 v7, v[76:79] offset:3072
    v_mfma_f32_16x16x32_bf16 v[32:35], a[12:15], v[152:155], v[32:35]
    v_mfma_f32_16x16x32_bf16 v[32:35], a[32:35], a[212:215], v[32:35]
    v_mfma_f32_16x16x32_bf16 v[32:35], a[52:55], v[164:167], v[32:35]
    ds_write_b128 v7, v[92:95] offset:4096
    v_mfma_f32_16x16x32_bf16 v[48:51], a[16:19], v[152:155], v[48:51]
    v_mfma_f32_16x16x32_bf16 v[48:51], a[36:39], a[212:215], v[48:51]
    v_mfma_f32_16x16x32_bf16 v[48:51], a[56:59], v[164:167], v[48:51]
    v_mfma_f32_16x16x32_bf16 v[64:67], v[144:147], v[152:155], v[64:67]
    v_mfma_f32_16x16x32_bf16 v[64:67], a[204:207], a[212:215], v[64:67]
    v_mfma_f32_16x16x32_bf16 v[64:67], v[156:159], v[164:167], v[64:67]
    v_mfma_f32_16x16x32_bf16 v[80:83], v[148:151], v[152:155], v[80:83]
    v_mfma_f32_16x16x32_bf16 v[80:83], a[208:211], a[212:215], v[80:83]
    v_mfma_f32_16x16x32_bf16 v[80:83], v[160:163], v[164:167], v[80:83]
    s_waitcnt lgkmcnt(15)
    v_fmac_f32 v16, v12, v110
    v_fmac_f32 v17, v12, v100
    v_fmac_f32 v18, v12, v111
    v_fmac_f32 v19, v12, v101
    v_fmac_f32 v32, v12, v112
    v_fmac_f32 v33, v12, v102
    v_fmac_f32 v34, v12, v113
    v_fmac_f32 v35, v12, v103
    v_fmac_f32 v48, v12, v114
    v_fmac_f32 v49, v12, v104
    v_fmac_f32 v50, v12, v115
    v_fmac_f32 v51, v12, v105
    v_fmac_f32 v64, v12, v116
    v_fmac_f32 v65, v12, v106
    v_fmac_f32 v66, v12, v117
    v_fmac_f32 v67, v12, v107
    v_fmac_f32 v80, v12, v118
    v_fmac_f32 v81, v12, v108
    v_fmac_f32 v82, v12, v119
    v_fmac_f32 v83, v12, v109
    s_mul_i32 s90, s70, 163840
    s_mul_i32 s91, s71, 320
    s_add_u32 s90, s90, s91
    s_waitcnt lgkmcnt(0)
    s_barrier
    ds_read_b128 v[128:131], v8 offset:0
    ds_read_b128 v[132:135], v8 offset:5120
    ds_read_b128 v[136:139], v8 offset:10240
    ds_read_b128 v[140:143], v8 offset:1024
    ds_read_b128 v[144:147], v8 offset:6144
    ds_read_b128 v[148:151], v8 offset:11264
    ds_read_b128 v[152:155], v8 offset:2048
    ds_read_b128 v[156:159], v8 offset:7168
    ds_read_b128 v[160:163], v8 offset:12288
    ds_read_b128 v[164:167], v8 offset:3072
    ds_read_b128 v[168:171], v8 offset:8192
    ds_read_b128 v[172:175], v8 offset:13312
    ds_read_b128 v[176:179], v8 offset:4096
    ds_read_b128 v[180:183], v8 offset:9216
    ds_read_b128 v[184:187], v8 offset:14336
    s_waitcnt lgkmcnt(13)
    v_add_f32 v128, v128, v132
    v_add_f32 v129, v129, v133
    v_add_f32 v130, v130, v134
    v_add_f32 v131, v131, v135
    s_waitcnt lgkmcnt(12)
    v_add_f32 v16, v16, v136
    v_add_f32 v17, v17, v137
    v_add_f32 v18, v18, v138
    v_add_f32 v19, v19, v139
    v_add_f32 v16, v16, v128
    v_add_f32 v17, v17, v129
    v_add_f32 v18, v18, v130
    v_add_f32 v19, v19, v131
    buffer_store_dwordx4 v[16:19], v9, s[48:51], s90 offen offset:0 sc1
    s_waitcnt lgkmcnt(10)
    v_add_f32 v140, v140, v144
    v_add_f32 v141, v141, v145
    v_add_f32 v142, v142, v146
    v_add_f32 v143, v143, v147
    s_waitcnt lgkmcnt(9)
    v_add_f32 v32, v32, v148
    v_add_f32 v33, v33, v149
    v_add_f32 v34, v34, v150
    v_add_f32 v35, v35, v151
    v_add_f32 v32, v32, v140
    v_add_f32 v33, v33, v141
    v_add_f32 v34, v34, v142
    v_add_f32 v35, v35, v143
    buffer_store_dwordx4 v[32:35], v9, s[48:51], s90 offen offset:64 sc1
    s_waitcnt lgkmcnt(7)
    v_add_f32 v152, v152, v156
    v_add_f32 v153, v153, v157
    v_add_f32 v154, v154, v158
    v_add_f32 v155, v155, v159
    s_waitcnt lgkmcnt(6)
    v_add_f32 v48, v48, v160
    v_add_f32 v49, v49, v161
    v_add_f32 v50, v50, v162
    v_add_f32 v51, v51, v163
    v_add_f32 v48, v48, v152
    v_add_f32 v49, v49, v153
    v_add_f32 v50, v50, v154
    v_add_f32 v51, v51, v155
    buffer_store_dwordx4 v[48:51], v9, s[48:51], s90 offen offset:128 sc1
    s_waitcnt lgkmcnt(4)
    v_add_f32 v164, v164, v168
    v_add_f32 v165, v165, v169
    v_add_f32 v166, v166, v170
    v_add_f32 v167, v167, v171
    s_waitcnt lgkmcnt(3)
    v_add_f32 v64, v64, v172
    v_add_f32 v65, v65, v173
    v_add_f32 v66, v66, v174
    v_add_f32 v67, v67, v175
    v_add_f32 v64, v64, v164
    v_add_f32 v65, v65, v165
    v_add_f32 v66, v66, v166
    v_add_f32 v67, v67, v167
    buffer_store_dwordx4 v[64:67], v9, s[48:51], s90 offen offset:192 sc1
    s_waitcnt lgkmcnt(1)
    v_add_f32 v176, v176, v180
    v_add_f32 v177, v177, v181
    v_add_f32 v178, v178, v182
    v_add_f32 v179, v179, v183
    s_waitcnt lgkmcnt(0)
    v_add_f32 v80, v80, v184
    v_add_f32 v81, v81, v185
    v_add_f32 v82, v82, v186
    v_add_f32 v83, v83, v187
    v_add_f32 v80, v80, v176
    v_add_f32 v81, v81, v177
    v_add_f32 v82, v82, v178
    v_add_f32 v83, v83, v179
    buffer_store_dwordx4 v[80:83], v9, s[48:51], s90 offen offset:256 sc1
L_exit:
    s_endpgm
.section .rodata,"a"
.p2align 6
.amdhsa_kernel gated_mix__ssm_conv_s5__dense_activation_relu__prompt_kernel
  .amdhsa_next_free_vgpr 512
  .amdhsa_next_free_sgpr 102
  .amdhsa_accum_offset 256
  .amdhsa_group_segment_fixed_size 0
  .amdhsa_kernarg_size 128
  .amdhsa_user_sgpr_count 2
  .amdhsa_user_sgpr_kernarg_segment_ptr 1
  .amdhsa_system_sgpr_workgroup_id_x 1
  .amdhsa_float_denorm_mode_32 3
.end_amdhsa_kernel
```
